```python
import torch

def _softmax(x, axis=-1):
    return torch.softmax(x, dim=axis)
def _gelu(x):
    return torch.nn.functional.gelu(x, approximate="tanh")
def _silu(x):
    return torch.nn.functional.silu(x)
def _sigmoid(x):
    return torch.sigmoid(x)
def _layernorm(x, axis=-1, eps=1e-5):
    m = x.mean(dim=axis, keepdim=True)
    v = x.var(dim=axis, keepdim=True, unbiased=False)
    return (x - m) / torch.sqrt(v + eps)
def _scatter_add(tgt, idx, src, axis=0):
    return tgt.clone().index_add_(axis, idx, src)
def _segment_sum(src, seg, n):
    out = torch.zeros((n,) + src.shape[1:], dtype=src.dtype)
    return out.index_add_(0, seg, src)
def _pad(x, pw):
    flat = tuple(v for pair in reversed(pw) for v in pair)
    return torch.nn.functional.pad(x, flat)

kernel_name = 'parallel_sum__mha_block__glu_gated_reglu__prompt'

def setup_inputs():

    _w = (lambda a: (lambda t: t.to(torch.bfloat16) if t.is_floating_point() else t)(torch.as_tensor(a)))
    def _A_setup():
        B, S, D, H = 1, 2048, 640, 32
        return {
            "x": _w((lambda *s: torch.randn(*s, dtype=torch.bfloat16) * 0.05)(B, S, D)),
            "wqkv": _w((lambda *s: torch.randn(*s, dtype=torch.bfloat16) * 0.05)(D, 3 * D)),
            "wo": _w((lambda *s: torch.randn(*s, dtype=torch.bfloat16) * 0.05)(D, D)),
        }
    _A_in = _A_setup()

    def _B_setup():
        B, S, D, F = 1, 2048, 640, 1536
        return {
            "x": _w((lambda *s: torch.randn(*s, dtype=torch.bfloat16) * 0.05)(B, S, D)),
            "W_gate": _w((lambda *s: torch.randn(*s, dtype=torch.bfloat16) * 0.4)(D, F) * (2.0 / D) ** 0.5),
            "W_up": _w((lambda *s: torch.randn(*s, dtype=torch.bfloat16) * 0.4)(D, F) * (2.0 / D) ** 0.5),
            "W_down": _w((lambda *s: torch.randn(*s, dtype=torch.bfloat16) * 0.4)(F, D) * (1.0 / F) ** 0.5),
        }
    _B_in = _B_setup()

    return {
        "A_x": _A_in["x"],
        "A_wqkv": _A_in["wqkv"],
        "A_wo": _A_in["wo"],
        "B_x": _B_in["x"],
        "B_W_gate": _B_in["W_gate"],
        "B_W_up": _B_in["W_up"],
        "B_W_down": _B_in["W_down"],
    }

def reference(A_x, A_wqkv, A_wo, B_x, B_W_gate, B_W_up, B_W_down):
    def _A_ref(x, wqkv, wo):
        B, S, D = x.shape
        H = 32
        Dh = D // H
        qkv = (lambda x, *d: x.permute(*d))((x @ wqkv).reshape(B, S, 3, H, Dh), 2, 0, 3, 1, 4)
        q, k, v = qkv[0], qkv[1], qkv[2]
        scores = torch.einsum("bhqd,bhkd->bhqk", q, k) * (Dh ** -0.5)
        p = _softmax(scores, axis=-1)
        o = torch.einsum("bhqk,bhkd->bhqd", p, v)
        return (lambda x, *d: x.permute(*d))(o, 0, 2, 1, 3).reshape(B, S, D) @ wo

    def _B_ref(x, W_gate, W_up, W_down):
        gate = torch.einsum("bsd,df->bsf", x, W_gate)
        up = torch.einsum("bsd,df->bsf", x, W_up)
        gate = gate * (lambda x, dt: x.to(dt))(gate > 0, gate.dtype)
        h = gate * up
        return torch.einsum("bsf,fd->bsd", h, W_down)

    x = A_x
    xn = _layernorm(x, axis=-1)
    return x + _A_ref(xn, A_wqkv, A_wo) + _B_ref(xn, B_W_gate, B_W_up, B_W_down)
```

```asm
; @launch kernel=k1_kernel grid=(256,1,1) block=(512,1,1) lds=161952
; @launch kernel=k2_kernel grid=(768,1,1) block=(256,1,1) lds=53248
; @launch kernel=k3_kernel grid=(256,1,1) block=(256,1,1) lds=61440
.amdgcn_target "amdgcn-amd-amdhsa--gfx950"
.text
.globl k1_kernel
.p2align 8
.type k1_kernel,@function
k1_kernel:
    s_cmp_ge_u32 s2, 256
    s_cbranch_scc1 LK1_end
    s_load_dwordx16 s[36:51], s[0:1], 0
    s_load_dwordx4 s[52:55], s[0:1], 64
    v_and_b32 v1, 63, v0
    v_lshrrev_b32 v2, 6, v0
    s_and_b32 s25, s2, 7
    v_readfirstlane_b32 s24, v2
    s_lshr_b32 s26, s2, 3
    s_and_b32 s80, s24, 3
    s_lshr_b32 s81, s24, 2
    s_cmp_lt_u32 s26, 4
    s_cbranch_scc1 LP
    s_sub_u32 s26, s26, 4
    s_and_b32 s27, s25, 1
    s_lshl_b32 s27, s27, 2
    s_and_b32 s28, s26, 3
    s_add_u32 s27, s27, s28
    s_lshl_b32 s29, s27, 8
    s_lshl_b32 s28, s24, 5
    s_add_u32 s29, s29, s28
    s_lshl_b32 s63, s24, 12
    v_and_b32 v5, 31, v1
    v_lshlrev_b32 v5, 2, v5
    v_lshrrev_b32 v24, 3, v1
    v_add_u32 v24, s29, v24
    v_mul_u32_u24 v24, 1280, v24
    v_lshrrev_b32 v25, 4, v1
    v_and_b32 v26, 7, v1
    v_xor_b32 v27, v26, v25
    v_lshl_add_u32 v10, v27, 4, v24
    v_xor_b32 v27, 4, v27
    v_lshl_add_u32 v11, v27, 4, v24
    v_add_u32 v12, 18432, v10
    v_add_u32 v13, 27648, v11
    v_add_u32 v11, 9216, v11
    v_and_b32 v24, 31, v1
    v_lshrrev_b32 v25, 5, v1
    v_bfe_u32 v26, v24, 1, 3
    v_xor_b32 v26, v26, v25
    v_lshlrev_b32 v24, 7, v24
    v_xor_b32 v27, 0, v26
    v_lshl_add_u32 v6, v27, 4, v24
    v_xor_b32 v27, 2, v26
    v_lshl_add_u32 v7, v27, 4, v24
    v_xor_b32 v27, 4, v26
    v_lshl_add_u32 v8, v27, 4, v24
    v_xor_b32 v27, 6, v26
    v_lshl_add_u32 v9, v27, 4, v24
    s_lshr_b32 s26, s26, 2
    s_lshr_b32 s56, s25, 1
    s_cmp_lt_u32 s26, 3
    s_cbranch_scc0 LK1_gu
    s_mul_i32 s28, s56, 3
    s_add_u32 s28, s28, s26
    s_cmp_lt_u32 s28, 8
    s_cbranch_scc1 LGQK
    s_branch LGV
LK1_gu:
    s_lshl_b32 s28, s56, 2
    s_add_u32 s28, s28, s26
    s_sub_u32 s28, s28, 3
    s_branch LGGU
LK1_end:
    s_endpgm
LGQK:
    s_mul_i32 s58, s28, 320
    s_lshr_b32 s59, s24, 1
    s_mul_i32 s59, s59, 2592
    s_and_b32 s57, s24, 1
    s_mul_i32 s57, s57, 1280
    s_add_u32 s59, s59, s57
    s_mul_i32 s60, s24, 80
    s_lshl_b32 s56, s24, 12
    s_add_u32 s59, s59, 98304
    s_mov_b32 s62, 3840
    v_add_u32 v6, s56, v6
    v_add_u32 v7, s56, v7
    v_add_u32 v8, s56, v8
    v_add_u32 v9, s56, v9
    v_add_u32 v24, s60, v1
    v_add_u32 v24, 0, v24
    v_mul_u32_u24 v25, 52429, v24
    v_lshrrev_b32 v25, 20, v25
    v_mul_u32_u24 v26, 20, v25
    v_sub_u32 v26, v24, v26
    v_mul_lo_u32 v25, v25, s62
    v_lshl_add_u32 v25, v26, 4, v25
    v_add_u32 v14, s58, v25
    v_add_u32 v24, s60, v1
    v_add_u32 v24, 64, v24
    v_mul_u32_u24 v25, 52429, v24
    v_lshrrev_b32 v25, 20, v25
    v_mul_u32_u24 v26, 20, v25
    v_sub_u32 v26, v24, v26
    v_mul_lo_u32 v25, v25, s62
    v_lshl_add_u32 v25, v26, 4, v25
    v_add_u32 v15, s58, v25
    v_subrev_u32 v15, 1024, v15
    s_mov_b32 s64, 0xffff
    s_mov_b32 s65, 0
    s_mov_b32 s30, 0
    s_mov_b32 s31, 0
    s_mov_b32 s32, 0
    s_mov_b32 s33, 0
    s_mov_b32 s66, 0
    s_mov_b32 s67, 0
    s_waitcnt lgkmcnt(0)
    s_mov_b32 s8, s36
    s_mov_b32 s9, s37
    s_mov_b32 s10, 2621440
    s_mov_b32 s11, 0x00020000
    s_mov_b32 s12, s38
    s_mov_b32 s13, s39
    s_mov_b32 s14, 2457600
    s_mov_b32 s15, 0x00020000
    s_add_u32 m0, s59, s33
    s_nop 0
    buffer_load_dwordx4 v14, s[12:15], s31 offen lds
    s_add_u32 m0, s63, s32
    s_nop 0
    buffer_load_dwordx4 v10, s[8:11], s30 offen offset:0 lds
    s_add_u32 m0, s59, s33
    s_mov_b64 exec, s[64:65]
    buffer_load_dwordx4 v15, s[12:15], s31 offen offset:1024 lds
    s_mov_b64 exec, -1
    s_add_u32 s33, s33, 12576
    s_cmp_eq_u32 s33, 62880
    s_cselect_b32 s33, 0, s33
    s_add_u32 s31, s31, 122880
    s_add_u32 m0, s63, s32
    s_nop 0
    buffer_load_dwordx4 v11, s[8:11], s30 offen offset:1024 lds
    s_add_u32 m0, s59, s33
    s_nop 0
    buffer_load_dwordx4 v14, s[12:15], s31 offen lds
    s_add_u32 m0, s63, s32
    s_nop 0
    buffer_load_dwordx4 v12, s[8:11], s30 offen offset:2048 lds
    s_add_u32 m0, s59, s33
    s_mov_b64 exec, s[64:65]
    buffer_load_dwordx4 v15, s[12:15], s31 offen offset:1024 lds
    s_mov_b64 exec, -1
    s_add_u32 s33, s33, 12576
    s_cmp_eq_u32 s33, 62880
    s_cselect_b32 s33, 0, s33
    s_add_u32 s31, s31, 122880
    s_add_u32 m0, s63, s32
    s_nop 0
    buffer_load_dwordx4 v13, s[8:11], s30 offen offset:3072 lds
    s_add_u32 s32, s32, 32768
    s_cmp_eq_u32 s32, 98304
    s_cselect_b32 s32, 0, s32
    s_add_u32 s30, s30, 128
    s_add_u32 m0, s59, s33
    s_nop 0
    buffer_load_dwordx4 v14, s[12:15], s31 offen lds
    s_add_u32 m0, s63, s32
    s_nop 0
    buffer_load_dwordx4 v10, s[8:11], s30 offen offset:0 lds
    s_add_u32 m0, s59, s33
    s_mov_b64 exec, s[64:65]
    buffer_load_dwordx4 v15, s[12:15], s31 offen offset:1024 lds
    s_mov_b64 exec, -1
    s_add_u32 s33, s33, 12576
    s_cmp_eq_u32 s33, 62880
    s_cselect_b32 s33, 0, s33
    s_add_u32 s31, s31, 122880
    s_add_u32 m0, s63, s32
    s_nop 0
    buffer_load_dwordx4 v11, s[8:11], s30 offen offset:1024 lds
    s_add_u32 m0, s59, s33
    s_nop 0
    buffer_load_dwordx4 v14, s[12:15], s31 offen lds
    s_add_u32 m0, s63, s32
    s_nop 0
    buffer_load_dwordx4 v12, s[8:11], s30 offen offset:2048 lds
    s_add_u32 m0, s59, s33
    s_mov_b64 exec, s[64:65]
    buffer_load_dwordx4 v15, s[12:15], s31 offen offset:1024 lds
    s_mov_b64 exec, -1
    s_add_u32 s33, s33, 12576
    s_cmp_eq_u32 s33, 62880
    s_cselect_b32 s33, 0, s33
    s_add_u32 s31, s31, 122880
    s_add_u32 m0, s63, s32
    s_nop 0
    buffer_load_dwordx4 v13, s[8:11], s30 offen offset:3072 lds
    s_add_u32 s32, s32, 32768
    s_cmp_eq_u32 s32, 98304
    s_cselect_b32 s32, 0, s32
    s_add_u32 s30, s30, 128
    s_mov_b32 s16, s54
    s_mov_b32 s17, s55
    s_mov_b32 s18, 268435456
    s_mov_b32 s19, 0x00020000
    s_mov_b32 s20, s52
    s_mov_b32 s21, s53
    s_mov_b32 s22, 256
    s_mov_b32 s23, 0x00020000
    v_bfe_u32 v26, v1, 2, 2
    v_mul_u32_u24 v26, 320, v26
    v_and_b32 v27, 3, v1
    v_lshl_add_u32 v26, v27, 3, v26
    v_lshrrev_b32 v24, 5, v1
    v_mul_u32_u24 v24, 2592, v24
    v_bfe_u32 v27, v1, 4, 1
    v_mul_u32_u24 v27, 32, v27
    v_add3_u32 v16, v24, v26, v27
    s_mov_b32 s61, 98304
    v_add_u32 v16, s61, v16
    v_mov_b32 v64, 0
    v_mov_b32 v65, 0
    v_mov_b32 v66, 0
    v_mov_b32 v67, 0
    v_mov_b32 v68, 0
    v_mov_b32 v69, 0
    v_mov_b32 v70, 0
    v_mov_b32 v71, 0
    v_mov_b32 v72, 0
    v_mov_b32 v73, 0
    v_mov_b32 v74, 0
    v_mov_b32 v75, 0
    v_mov_b32 v76, 0
    v_mov_b32 v77, 0
    v_mov_b32 v78, 0
    v_mov_b32 v79, 0
    v_mov_b32 v80, 0
    v_mov_b32 v81, 0
    v_mov_b32 v82, 0
    v_mov_b32 v83, 0
    v_mov_b32 v84, 0
    v_mov_b32 v85, 0
    v_mov_b32 v86, 0
    v_mov_b32 v87, 0
    v_mov_b32 v88, 0
    v_mov_b32 v89, 0
    v_mov_b32 v90, 0
    v_mov_b32 v91, 0
    v_mov_b32 v92, 0
    v_mov_b32 v93, 0
    v_mov_b32 v94, 0
    v_mov_b32 v95, 0
    v_mov_b32 v96, 0
    v_mov_b32 v97, 0
    v_mov_b32 v98, 0
    v_mov_b32 v99, 0
    v_mov_b32 v100, 0
    v_mov_b32 v101, 0
    v_mov_b32 v102, 0
    v_mov_b32 v103, 0
    v_mov_b32 v104, 0
    v_mov_b32 v105, 0
    v_mov_b32 v106, 0
    v_mov_b32 v107, 0
    v_mov_b32 v108, 0
    v_mov_b32 v109, 0
    v_mov_b32 v110, 0
    v_mov_b32 v111, 0
    v_mov_b32 v112, 0
    v_mov_b32 v113, 0
    v_mov_b32 v114, 0
    v_mov_b32 v115, 0
    v_mov_b32 v116, 0
    v_mov_b32 v117, 0
    v_mov_b32 v118, 0
    v_mov_b32 v119, 0
    v_mov_b32 v120, 0
    v_mov_b32 v121, 0
    v_mov_b32 v122, 0
    v_mov_b32 v123, 0
    v_mov_b32 v124, 0
    v_mov_b32 v125, 0
    v_mov_b32 v126, 0
    v_mov_b32 v127, 0
    v_mov_b32 v128, 0
    v_mov_b32 v129, 0
    v_mov_b32 v130, 0
    v_mov_b32 v131, 0
    v_mov_b32 v132, 0
    v_mov_b32 v133, 0
    v_mov_b32 v134, 0
    v_mov_b32 v135, 0
    v_mov_b32 v136, 0
    v_mov_b32 v137, 0
    v_mov_b32 v138, 0
    v_mov_b32 v139, 0
    v_mov_b32 v140, 0
    v_mov_b32 v141, 0
    v_mov_b32 v142, 0
    v_mov_b32 v143, 0
    s_waitcnt vmcnt(8) lgkmcnt(0)
    s_barrier
    ds_read_b128 v[168:171], v6 offset:0
    ds_read_b64_tr_b16 v[172:173], v16 offset:0
    ds_read_b64_tr_b16 v[174:175], v16 offset:1280
    ds_read_b64_tr_b16 v[176:177], v16 offset:64
    ds_read_b64_tr_b16 v[178:179], v16 offset:1344
    ds_read_b64_tr_b16 v[180:181], v16 offset:128
    ds_read_b64_tr_b16 v[182:183], v16 offset:1408
    ds_read_b64_tr_b16 v[184:185], v16 offset:192
    ds_read_b64_tr_b16 v[186:187], v16 offset:1472
    ds_read_b64_tr_b16 v[188:189], v16 offset:256
    ds_read_b64_tr_b16 v[190:191], v16 offset:1536
    s_add_u32 s69, s66, 32768
    s_cmp_eq_u32 s69, 98304
    s_cselect_b32 s69, 0, s69
    s_sub_u32 s68, s69, s66
    s_mov_b32 s66, s69
    v_add_u32 v6, s68, v6
    s_mov_b32 s34, 8
    s_branch LGQK_in
.p2align 6
LGQK_loop:
    s_waitcnt vmcnt(9)
    s_barrier
LGQK_in:
    s_waitcnt lgkmcnt(0)
    v_mfma_f32_32x32x16_bf16 v[64:79], v[172:175], v[168:171], v[64:79]
    ds_read_b128 v[192:195], v7 offset:0
    v_add_u32 v7, s68, v7
    ds_read_b64_tr_b16 v[196:197], v16 offset:5184
    ds_read_b64_tr_b16 v[198:199], v16 offset:6464
    ds_read_b64_tr_b16 v[200:201], v16 offset:5248
    v_mfma_f32_32x32x16_bf16 v[80:95], v[176:179], v[168:171], v[80:95]
    ds_read_b64_tr_b16 v[202:203], v16 offset:6528
    ds_read_b64_tr_b16 v[204:205], v16 offset:5312
    ds_read_b64_tr_b16 v[206:207], v16 offset:6592
    ds_read_b64_tr_b16 v[208:209], v16 offset:5376
    s_add_u32 m0, s59, s33
    s_nop 0
    buffer_load_dwordx4 v14, s[12:15], s31 offen lds
    v_mfma_f32_32x32x16_bf16 v[96:111], v[180:183], v[168:171], v[96:111]
    ds_read_b64_tr_b16 v[210:211], v16 offset:6656
    ds_read_b64_tr_b16 v[212:213], v16 offset:5440
    ds_read_b64_tr_b16 v[214:215], v16 offset:6720
    v_mfma_f32_32x32x16_bf16 v[112:127], v[184:187], v[168:171], v[112:127]
    s_add_u32 m0, s63, s32
    s_nop 0
    buffer_load_dwordx4 v10, s[8:11], s30 offen offset:0 lds
    v_mfma_f32_32x32x16_bf16 v[128:143], v[188:191], v[168:171], v[128:143]
    s_waitcnt lgkmcnt(0)
    s_add_u32 s69, s67, 12576
    s_cmp_eq_u32 s69, 62880
    s_cselect_b32 s69, 0, s69
    s_sub_u32 s70, s69, s67
    s_mov_b32 s67, s69
    v_add_u32 v16, s70, v16
    v_mfma_f32_32x32x16_bf16 v[64:79], v[196:199], v[192:195], v[64:79]
    ds_read_b128 v[168:171], v8 offset:0
    v_add_u32 v8, s68, v8
    ds_read_b64_tr_b16 v[172:173], v16 offset:0
    ds_read_b64_tr_b16 v[174:175], v16 offset:1280
    ds_read_b64_tr_b16 v[176:177], v16 offset:64
    v_mfma_f32_32x32x16_bf16 v[80:95], v[200:203], v[192:195], v[80:95]
    ds_read_b64_tr_b16 v[178:179], v16 offset:1344
    ds_read_b64_tr_b16 v[180:181], v16 offset:128
    ds_read_b64_tr_b16 v[182:183], v16 offset:1408
    ds_read_b64_tr_b16 v[184:185], v16 offset:192
    s_add_u32 m0, s59, s33
    s_mov_b64 exec, s[64:65]
    buffer_load_dwordx4 v15, s[12:15], s31 offen offset:1024 lds
    s_mov_b64 exec, -1
    s_add_u32 s33, s33, 12576
    s_cmp_eq_u32 s33, 62880
    s_cselect_b32 s33, 0, s33
    s_add_u32 s31, s31, 122880
    v_mfma_f32_32x32x16_bf16 v[96:111], v[204:207], v[192:195], v[96:111]
    ds_read_b64_tr_b16 v[186:187], v16 offset:1472
    ds_read_b64_tr_b16 v[188:189], v16 offset:256
    ds_read_b64_tr_b16 v[190:191], v16 offset:1536
    v_mfma_f32_32x32x16_bf16 v[112:127], v[208:211], v[192:195], v[112:127]
    s_add_u32 m0, s63, s32
    s_nop 0
    buffer_load_dwordx4 v11, s[8:11], s30 offen offset:1024 lds
    v_mfma_f32_32x32x16_bf16 v[128:143], v[212:215], v[192:195], v[128:143]
    s_waitcnt vmcnt(9)
    s_barrier
    s_waitcnt lgkmcnt(0)
    v_mfma_f32_32x32x16_bf16 v[64:79], v[172:175], v[168:171], v[64:79]
    ds_read_b128 v[192:195], v9 offset:0
    v_add_u32 v9, s68, v9
    ds_read_b64_tr_b16 v[196:197], v16 offset:5184
    ds_read_b64_tr_b16 v[198:199], v16 offset:6464
    ds_read_b64_tr_b16 v[200:201], v16 offset:5248
    v_mfma_f32_32x32x16_bf16 v[80:95], v[176:179], v[168:171], v[80:95]
    ds_read_b64_tr_b16 v[202:203], v16 offset:6528
    ds_read_b64_tr_b16 v[204:205], v16 offset:5312
    ds_read_b64_tr_b16 v[206:207], v16 offset:6592
    ds_read_b64_tr_b16 v[208:209], v16 offset:5376
    s_add_u32 m0, s59, s33
    s_nop 0
    buffer_load_dwordx4 v14, s[12:15], s31 offen lds
    v_mfma_f32_32x32x16_bf16 v[96:111], v[180:183], v[168:171], v[96:111]
    ds_read_b64_tr_b16 v[210:211], v16 offset:6656
    ds_read_b64_tr_b16 v[212:213], v16 offset:5440
    ds_read_b64_tr_b16 v[214:215], v16 offset:6720
    v_mfma_f32_32x32x16_bf16 v[112:127], v[184:187], v[168:171], v[112:127]
    s_add_u32 m0, s63, s32
    s_nop 0
    buffer_load_dwordx4 v12, s[8:11], s30 offen offset:2048 lds
    v_mfma_f32_32x32x16_bf16 v[128:143], v[188:191], v[168:171], v[128:143]
    s_waitcnt vmcnt(6) lgkmcnt(0)
    s_add_u32 s69, s67, 12576
    s_cmp_eq_u32 s69, 62880
    s_cselect_b32 s69, 0, s69
    s_sub_u32 s70, s69, s67
    s_mov_b32 s67, s69
    v_add_u32 v16, s70, v16
    v_mfma_f32_32x32x16_bf16 v[64:79], v[196:199], v[192:195], v[64:79]
    ds_read_b128 v[168:171], v6 offset:0
    s_add_u32 s69, s66, 32768
    s_cmp_eq_u32 s69, 98304
    s_cselect_b32 s69, 0, s69
    s_sub_u32 s68, s69, s66
    s_mov_b32 s66, s69
    v_add_u32 v6, s68, v6
    ds_read_b64_tr_b16 v[172:173], v16 offset:0
    ds_read_b64_tr_b16 v[174:175], v16 offset:1280
    ds_read_b64_tr_b16 v[176:177], v16 offset:64
    v_mfma_f32_32x32x16_bf16 v[80:95], v[200:203], v[192:195], v[80:95]
    ds_read_b64_tr_b16 v[178:179], v16 offset:1344
    ds_read_b64_tr_b16 v[180:181], v16 offset:128
    ds_read_b64_tr_b16 v[182:183], v16 offset:1408
    ds_read_b64_tr_b16 v[184:185], v16 offset:192
    s_add_u32 m0, s59, s33
    s_mov_b64 exec, s[64:65]
    buffer_load_dwordx4 v15, s[12:15], s31 offen offset:1024 lds
    s_mov_b64 exec, -1
    s_add_u32 s33, s33, 12576
    s_cmp_eq_u32 s33, 62880
    s_cselect_b32 s33, 0, s33
    s_add_u32 s31, s31, 122880
    v_mfma_f32_32x32x16_bf16 v[96:111], v[204:207], v[192:195], v[96:111]
    ds_read_b64_tr_b16 v[186:187], v16 offset:1472
    ds_read_b64_tr_b16 v[188:189], v16 offset:256
    ds_read_b64_tr_b16 v[190:191], v16 offset:1536
    v_mfma_f32_32x32x16_bf16 v[112:127], v[208:211], v[192:195], v[112:127]
    s_add_u32 m0, s63, s32
    s_nop 0
    buffer_load_dwordx4 v13, s[8:11], s30 offen offset:3072 lds
    s_add_u32 s32, s32, 32768
    s_cmp_eq_u32 s32, 98304
    s_cselect_b32 s32, 0, s32
    s_add_u32 s30, s30, 128
    v_mfma_f32_32x32x16_bf16 v[128:143], v[212:215], v[192:195], v[128:143]
    s_sub_u32 s34, s34, 1
    s_cmp_lg_u32 s34, 0
    s_cbranch_scc1 LGQK_loop
    s_waitcnt vmcnt(9)
    s_barrier
    s_waitcnt lgkmcnt(0)
    v_mfma_f32_32x32x16_bf16 v[64:79], v[172:175], v[168:171], v[64:79]
    ds_read_b128 v[192:195], v7 offset:0
    v_add_u32 v7, s68, v7
    ds_read_b64_tr_b16 v[196:197], v16 offset:5184
    ds_read_b64_tr_b16 v[198:199], v16 offset:6464
    ds_read_b64_tr_b16 v[200:201], v16 offset:5248
    v_mfma_f32_32x32x16_bf16 v[80:95], v[176:179], v[168:171], v[80:95]
    ds_read_b64_tr_b16 v[202:203], v16 offset:6528
    ds_read_b64_tr_b16 v[204:205], v16 offset:5312
    ds_read_b64_tr_b16 v[206:207], v16 offset:6592
    ds_read_b64_tr_b16 v[208:209], v16 offset:5376
    v_mfma_f32_32x32x16_bf16 v[96:111], v[180:183], v[168:171], v[96:111]
    ds_read_b64_tr_b16 v[210:211], v16 offset:6656
    ds_read_b64_tr_b16 v[212:213], v16 offset:5440
    ds_read_b64_tr_b16 v[214:215], v16 offset:6720
    v_mfma_f32_32x32x16_bf16 v[112:127], v[184:187], v[168:171], v[112:127]
    v_mfma_f32_32x32x16_bf16 v[128:143], v[188:191], v[168:171], v[128:143]
    s_waitcnt lgkmcnt(0)
    s_add_u32 s69, s67, 12576
    s_cmp_eq_u32 s69, 62880
    s_cselect_b32 s69, 0, s69
    s_sub_u32 s70, s69, s67
    s_mov_b32 s67, s69
    v_add_u32 v16, s70, v16
    v_mfma_f32_32x32x16_bf16 v[64:79], v[196:199], v[192:195], v[64:79]
    ds_read_b128 v[168:171], v8 offset:0
    v_add_u32 v8, s68, v8
    ds_read_b64_tr_b16 v[172:173], v16 offset:0
    ds_read_b64_tr_b16 v[174:175], v16 offset:1280
    ds_read_b64_tr_b16 v[176:177], v16 offset:64
    v_mfma_f32_32x32x16_bf16 v[80:95], v[200:203], v[192:195], v[80:95]
    ds_read_b64_tr_b16 v[178:179], v16 offset:1344
    ds_read_b64_tr_b16 v[180:181], v16 offset:128
    ds_read_b64_tr_b16 v[182:183], v16 offset:1408
    ds_read_b64_tr_b16 v[184:185], v16 offset:192
    v_mfma_f32_32x32x16_bf16 v[96:111], v[204:207], v[192:195], v[96:111]
    ds_read_b64_tr_b16 v[186:187], v16 offset:1472
    ds_read_b64_tr_b16 v[188:189], v16 offset:256
    ds_read_b64_tr_b16 v[190:191], v16 offset:1536
    v_mfma_f32_32x32x16_bf16 v[112:127], v[208:211], v[192:195], v[112:127]
    v_mfma_f32_32x32x16_bf16 v[128:143], v[212:215], v[192:195], v[128:143]
    s_waitcnt vmcnt(5)
    s_barrier
    s_waitcnt lgkmcnt(0)
    v_mfma_f32_32x32x16_bf16 v[64:79], v[172:175], v[168:171], v[64:79]
    ds_read_b128 v[192:195], v9 offset:0
    v_add_u32 v9, s68, v9
    ds_read_b64_tr_b16 v[196:197], v16 offset:5184
    ds_read_b64_tr_b16 v[198:199], v16 offset:6464
    ds_read_b64_tr_b16 v[200:201], v16 offset:5248
    v_mfma_f32_32x32x16_bf16 v[80:95], v[176:179], v[168:171], v[80:95]
    ds_read_b64_tr_b16 v[202:203], v16 offset:6528
    ds_read_b64_tr_b16 v[204:205], v16 offset:5312
    ds_read_b64_tr_b16 v[206:207], v16 offset:6592
    ds_read_b64_tr_b16 v[208:209], v16 offset:5376
    v_mfma_f32_32x32x16_bf16 v[96:111], v[180:183], v[168:171], v[96:111]
    ds_read_b64_tr_b16 v[210:211], v16 offset:6656
    ds_read_b64_tr_b16 v[212:213], v16 offset:5440
    ds_read_b64_tr_b16 v[214:215], v16 offset:6720
    v_mfma_f32_32x32x16_bf16 v[112:127], v[184:187], v[168:171], v[112:127]
    v_mfma_f32_32x32x16_bf16 v[128:143], v[188:191], v[168:171], v[128:143]
    s_waitcnt vmcnt(0) lgkmcnt(0)
    s_add_u32 s69, s67, 12576
    s_cmp_eq_u32 s69, 62880
    s_cselect_b32 s69, 0, s69
    s_sub_u32 s70, s69, s67
    s_mov_b32 s67, s69
    v_add_u32 v16, s70, v16
    v_mfma_f32_32x32x16_bf16 v[64:79], v[196:199], v[192:195], v[64:79]
    ds_read_b128 v[168:171], v6 offset:0
    s_add_u32 s69, s66, 32768
    s_cmp_eq_u32 s69, 98304
    s_cselect_b32 s69, 0, s69
    s_sub_u32 s68, s69, s66
    s_mov_b32 s66, s69
    v_add_u32 v6, s68, v6
    ds_read_b64_tr_b16 v[172:173], v16 offset:0
    ds_read_b64_tr_b16 v[174:175], v16 offset:1280
    ds_read_b64_tr_b16 v[176:177], v16 offset:64
    v_mfma_f32_32x32x16_bf16 v[80:95], v[200:203], v[192:195], v[80:95]
    ds_read_b64_tr_b16 v[178:179], v16 offset:1344
    ds_read_b64_tr_b16 v[180:181], v16 offset:128
    ds_read_b64_tr_b16 v[182:183], v16 offset:1408
    ds_read_b64_tr_b16 v[184:185], v16 offset:192
    v_mfma_f32_32x32x16_bf16 v[96:111], v[204:207], v[192:195], v[96:111]
    ds_read_b64_tr_b16 v[186:187], v16 offset:1472
    ds_read_b64_tr_b16 v[188:189], v16 offset:256
    ds_read_b64_tr_b16 v[190:191], v16 offset:1536
    v_mfma_f32_32x32x16_bf16 v[112:127], v[208:211], v[192:195], v[112:127]
    v_mfma_f32_32x32x16_bf16 v[128:143], v[212:215], v[192:195], v[128:143]
    s_waitcnt vmcnt(0)
    s_barrier
    buffer_load_dword v24, v5, s[20:23], 0 offen sc1
    s_waitcnt lgkmcnt(0)
    v_mfma_f32_32x32x16_bf16 v[64:79], v[172:175], v[168:171], v[64:79]
    ds_read_b128 v[192:195], v7 offset:0
    v_add_u32 v7, s68, v7
    ds_read_b64_tr_b16 v[196:197], v16 offset:5184
    ds_read_b64_tr_b16 v[198:199], v16 offset:6464
    ds_read_b64_tr_b16 v[200:201], v16 offset:5248
    v_mfma_f32_32x32x16_bf16 v[80:95], v[176:179], v[168:171], v[80:95]
    ds_read_b64_tr_b16 v[202:203], v16 offset:6528
    ds_read_b64_tr_b16 v[204:205], v16 offset:5312
    ds_read_b64_tr_b16 v[206:207], v16 offset:6592
    ds_read_b64_tr_b16 v[208:209], v16 offset:5376
    v_mfma_f32_32x32x16_bf16 v[96:111], v[180:183], v[168:171], v[96:111]
    ds_read_b64_tr_b16 v[210:211], v16 offset:6656
    ds_read_b64_tr_b16 v[212:213], v16 offset:5440
    ds_read_b64_tr_b16 v[214:215], v16 offset:6720
    v_mfma_f32_32x32x16_bf16 v[112:127], v[184:187], v[168:171], v[112:127]
    v_mfma_f32_32x32x16_bf16 v[128:143], v[188:191], v[168:171], v[128:143]
    s_waitcnt vmcnt(0)
    v_cmp_eq_u32 vcc, 0, v24
    s_mov_b32 s78, 0
    s_nop 3
    s_cmp_eq_u64 vcc, 0
    s_cbranch_scc0 LGQK_notyet
    s_mov_b32 s78, 1
    s_mov_b32 s76, s29
    v_and_b32 v25, 31, v1
    v_add_u32 v26, s76, v25
    v_lshlrev_b32 v26, 2, v26
    s_mov_b32 s69, 19922944
    s_mov_b32 s70, 19931136
    buffer_load_dword v28, v26, s[16:19], s69 offen offset:0 sc1
    buffer_load_dword v30, v26, s[16:19], s70 offen offset:0 sc1
    v_lshlrev_b32 v32, 2, v25
    s_mul_i32 s69, s28, 640
    s_add_u32 s69, s69, 19939328
    buffer_load_dword v228, v32, s[16:19], s69 offen offset:0 sc1
    buffer_load_dword v229, v32, s[16:19], s69 offen offset:128 sc1
    buffer_load_dword v230, v32, s[16:19], s69 offen offset:256 sc1
    buffer_load_dword v231, v32, s[16:19], s69 offen offset:384 sc1
    buffer_load_dword v232, v32, s[16:19], s69 offen offset:512 sc1
    s_add_u32 s69, s69, 19968
    buffer_load_dword v233, v32, s[16:19], s69 offen offset:0 sc1
    buffer_load_dword v234, v32, s[16:19], s69 offen offset:128 sc1
    buffer_load_dword v235, v32, s[16:19], s69 offen offset:256 sc1
    buffer_load_dword v236, v32, s[16:19], s69 offen offset:384 sc1
    buffer_load_dword v237, v32, s[16:19], s69 offen offset:512 sc1
    s_add_u32 s69, s69, 19968
    buffer_load_dword v238, v32, s[16:19], s69 offen offset:0 sc1
    buffer_load_dword v239, v32, s[16:19], s69 offen offset:128 sc1
    buffer_load_dword v240, v32, s[16:19], s69 offen offset:256 sc1
    buffer_load_dword v241, v32, s[16:19], s69 offen offset:384 sc1
    buffer_load_dword v242, v32, s[16:19], s69 offen offset:512 sc1
    s_add_u32 s69, s69, 19968
    buffer_load_dword v243, v32, s[16:19], s69 offen offset:0 sc1
    buffer_load_dword v244, v32, s[16:19], s69 offen offset:128 sc1
    buffer_load_dword v245, v32, s[16:19], s69 offen offset:256 sc1
    buffer_load_dword v246, v32, s[16:19], s69 offen offset:384 sc1
    buffer_load_dword v247, v32, s[16:19], s69 offen offset:512 sc1
LGQK_notyet:
    s_waitcnt lgkmcnt(0)
    s_add_u32 s69, s67, 12576
    s_cmp_eq_u32 s69, 62880
    s_cselect_b32 s69, 0, s69
    s_sub_u32 s70, s69, s67
    s_mov_b32 s67, s69
    v_add_u32 v16, s70, v16
    v_mfma_f32_32x32x16_bf16 v[64:79], v[196:199], v[192:195], v[64:79]
    ds_read_b128 v[168:171], v8 offset:0
    v_add_u32 v8, s68, v8
    ds_read_b64_tr_b16 v[172:173], v16 offset:0
    ds_read_b64_tr_b16 v[174:175], v16 offset:1280
    ds_read_b64_tr_b16 v[176:177], v16 offset:64
    v_mfma_f32_32x32x16_bf16 v[80:95], v[200:203], v[192:195], v[80:95]
    ds_read_b64_tr_b16 v[178:179], v16 offset:1344
    ds_read_b64_tr_b16 v[180:181], v16 offset:128
    ds_read_b64_tr_b16 v[182:183], v16 offset:1408
    ds_read_b64_tr_b16 v[184:185], v16 offset:192
    v_mfma_f32_32x32x16_bf16 v[96:111], v[204:207], v[192:195], v[96:111]
    ds_read_b64_tr_b16 v[186:187], v16 offset:1472
    ds_read_b64_tr_b16 v[188:189], v16 offset:256
    ds_read_b64_tr_b16 v[190:191], v16 offset:1536
    v_mfma_f32_32x32x16_bf16 v[112:127], v[208:211], v[192:195], v[112:127]
    v_mfma_f32_32x32x16_bf16 v[128:143], v[212:215], v[192:195], v[128:143]
    s_waitcnt lgkmcnt(0)
    v_mfma_f32_32x32x16_bf16 v[64:79], v[172:175], v[168:171], v[64:79]
    ds_read_b128 v[192:195], v9 offset:0
    v_add_u32 v9, s68, v9
    ds_read_b64_tr_b16 v[196:197], v16 offset:5184
    ds_read_b64_tr_b16 v[198:199], v16 offset:6464
    ds_read_b64_tr_b16 v[200:201], v16 offset:5248
    v_mfma_f32_32x32x16_bf16 v[80:95], v[176:179], v[168:171], v[80:95]
    ds_read_b64_tr_b16 v[202:203], v16 offset:6528
    ds_read_b64_tr_b16 v[204:205], v16 offset:5312
    ds_read_b64_tr_b16 v[206:207], v16 offset:6592
    ds_read_b64_tr_b16 v[208:209], v16 offset:5376
    v_mfma_f32_32x32x16_bf16 v[96:111], v[180:183], v[168:171], v[96:111]
    ds_read_b64_tr_b16 v[210:211], v16 offset:6656
    ds_read_b64_tr_b16 v[212:213], v16 offset:5440
    ds_read_b64_tr_b16 v[214:215], v16 offset:6720
    v_mfma_f32_32x32x16_bf16 v[112:127], v[184:187], v[168:171], v[112:127]
    v_mfma_f32_32x32x16_bf16 v[128:143], v[188:191], v[168:171], v[128:143]
    s_waitcnt lgkmcnt(0)
    v_mfma_f32_32x32x16_bf16 v[64:79], v[196:199], v[192:195], v[64:79]
    v_mfma_f32_32x32x16_bf16 v[80:95], v[200:203], v[192:195], v[80:95]
    v_mfma_f32_32x32x16_bf16 v[96:111], v[204:207], v[192:195], v[96:111]
    v_mfma_f32_32x32x16_bf16 v[112:127], v[208:211], v[192:195], v[112:127]
    v_mfma_f32_32x32x16_bf16 v[128:143], v[212:215], v[192:195], v[128:143]
    s_cmp_lg_u32 s78, 0
    s_cbranch_scc1 LGQK_have
LGQK_poll:
    buffer_load_dword v24, v5, s[20:23], 0 offen sc1
    s_waitcnt vmcnt(0)
    v_cmp_eq_u32 vcc, 0, v24
    s_nop 4
    s_cmp_eq_u64 vcc, 0
    s_cbranch_scc1 LGQK_pollok
    s_sleep 1
    s_branch LGQK_poll
LGQK_pollok:
    s_mov_b32 s76, s29
    v_and_b32 v25, 31, v1
    v_add_u32 v26, s76, v25
    v_lshlrev_b32 v26, 2, v26
    s_mov_b32 s69, 19922944
    s_mov_b32 s70, 19931136
    buffer_load_dword v28, v26, s[16:19], s69 offen offset:0 sc1
    buffer_load_dword v30, v26, s[16:19], s70 offen offset:0 sc1
    v_lshlrev_b32 v32, 2, v25
    s_mul_i32 s69, s28, 640
    s_add_u32 s69, s69, 19939328
    buffer_load_dword v228, v32, s[16:19], s69 offen offset:0 sc1
    buffer_load_dword v229, v32, s[16:19], s69 offen offset:128 sc1
    buffer_load_dword v230, v32, s[16:19], s69 offen offset:256 sc1
    buffer_load_dword v231, v32, s[16:19], s69 offen offset:384 sc1
    buffer_load_dword v232, v32, s[16:19], s69 offen offset:512 sc1
    s_add_u32 s69, s69, 19968
    buffer_load_dword v233, v32, s[16:19], s69 offen offset:0 sc1
    buffer_load_dword v234, v32, s[16:19], s69 offen offset:128 sc1
    buffer_load_dword v235, v32, s[16:19], s69 offen offset:256 sc1
    buffer_load_dword v236, v32, s[16:19], s69 offen offset:384 sc1
    buffer_load_dword v237, v32, s[16:19], s69 offen offset:512 sc1
    s_add_u32 s69, s69, 19968
    buffer_load_dword v238, v32, s[16:19], s69 offen offset:0 sc1
    buffer_load_dword v239, v32, s[16:19], s69 offen offset:128 sc1
    buffer_load_dword v240, v32, s[16:19], s69 offen offset:256 sc1
    buffer_load_dword v241, v32, s[16:19], s69 offen offset:384 sc1
    buffer_load_dword v242, v32, s[16:19], s69 offen offset:512 sc1
    s_add_u32 s69, s69, 19968
    buffer_load_dword v243, v32, s[16:19], s69 offen offset:0 sc1
    buffer_load_dword v244, v32, s[16:19], s69 offen offset:128 sc1
    buffer_load_dword v245, v32, s[16:19], s69 offen offset:256 sc1
    buffer_load_dword v246, v32, s[16:19], s69 offen offset:384 sc1
    buffer_load_dword v247, v32, s[16:19], s69 offen offset:512 sc1
LGQK_have:
    s_waitcnt vmcnt(0)
    s_mov_b32 s64, -1
    s_mov_b32 s65, 0
    v_add_f32 v34, v228, v233
    v_add_f32 v238, v238, v243
    v_add_f32 v34, v34, v238
    v_add_f32 v35, v229, v234
    v_add_f32 v239, v239, v244
    v_add_f32 v35, v35, v239
    v_add_f32 v36, v230, v235
    v_add_f32 v240, v240, v245
    v_add_f32 v36, v36, v240
    v_add_f32 v37, v231, v236
    v_add_f32 v241, v241, v246
    v_add_f32 v37, v37, v241
    v_add_f32 v38, v232, v237
    v_add_f32 v242, v242, v247
    v_add_f32 v38, v38, v242
    v_xor_b32 v24, 0x80000000, v28
    v_lshrrev_b32 v25, 16, v24
    v_or_b32 v26, v25, v24
    v_cndmask_b32 v168, 0, v26, s[64:65]
    v_cndmask_b32 v169, 0, v25, s[64:65]
    v_mov_b32 v170, 0
    v_mov_b32 v171, 0
    v_and_b32 v24, 0xffff0000, v34
    v_sub_f32 v25, v34, v24
    v_and_b32 v26, 0xffff0000, v25
    v_sub_f32 v25, v25, v26
    v_lshrrev_b32 v24, 16, v24
    v_or_b32 v216, v24, v26
    v_lshrrev_b32 v217, 16, v25
    v_mov_b32 v218, 0
    v_mov_b32 v219, 0
    v_and_b32 v24, 0xffff0000, v35
    v_sub_f32 v25, v35, v24
    v_and_b32 v26, 0xffff0000, v25
    v_sub_f32 v25, v25, v26
    v_lshrrev_b32 v24, 16, v24
    v_or_b32 v220, v24, v26
    v_lshrrev_b32 v221, 16, v25
    v_mov_b32 v222, 0
    v_mov_b32 v223, 0
    v_mfma_f32_32x32x16_bf16 v[64:79], v[216:219], v[168:171], v[64:79]
    v_and_b32 v24, 0xffff0000, v36
    v_sub_f32 v25, v36, v24
    v_and_b32 v26, 0xffff0000, v25
    v_sub_f32 v25, v25, v26
    v_lshrrev_b32 v24, 16, v24
    v_or_b32 v224, v24, v26
    v_lshrrev_b32 v225, 16, v25
    v_mov_b32 v226, 0
    v_mov_b32 v227, 0
    v_mfma_f32_32x32x16_bf16 v[80:95], v[220:223], v[168:171], v[80:95]
    v_and_b32 v24, 0xffff0000, v37
    v_sub_f32 v25, v37, v24
    v_and_b32 v26, 0xffff0000, v25
    v_sub_f32 v25, v25, v26
    v_lshrrev_b32 v24, 16, v24
    v_or_b32 v176, v24, v26
    v_lshrrev_b32 v177, 16, v25
    v_mov_b32 v178, 0
    v_mov_b32 v179, 0
    v_mfma_f32_32x32x16_bf16 v[96:111], v[224:227], v[168:171], v[96:111]
    v_and_b32 v24, 0xffff0000, v38
    v_sub_f32 v25, v38, v24
    v_and_b32 v26, 0xffff0000, v25
    v_sub_f32 v25, v25, v26
    v_lshrrev_b32 v24, 16, v24
    v_or_b32 v180, v24, v26
    v_lshrrev_b32 v181, 16, v25
    v_mov_b32 v182, 0
    v_mov_b32 v183, 0
    s_nop 1
    v_mfma_f32_32x32x16_bf16 v[112:127], v[176:179], v[168:171], v[112:127]
    v_mfma_f32_32x32x16_bf16 v[128:143], v[180:183], v[168:171], v[128:143]
    s_lshr_b32 s69, s76, 5
    s_cmp_lt_u32 s28, 4
    s_cselect_b32 s70, 0x3ea52b5c, 1.0
    v_mul_f32 v4, s70, v30
    s_cselect_b32 s71, 0, 2621440
    s_and_b32 s72, s28, 3
    s_mul_i32 s72, s72, 655360
    s_add_u32 s71, s71, s72
    s_mul_i32 s72, s69, 1280
    s_add_u32 s71, s71, s72
    v_lshlrev_b32 v2, 4, v1
    v_and_b32 v3, 31, v1
    v_lshlrev_b32 v3, 3, v3
    v_lshrrev_b32 v5, 5, v1
    s_mov_b32 s72, 81920
    v_mul_lo_u32 v5, v5, s72
    v_add3_u32 v3, v3, v5, 0
    v_add_u32 v3, 1024, v3
    v_mul_f32 v64, v64, v4
    v_mul_f32 v65, v65, v4
    v_mul_f32 v66, v66, v4
    v_mul_f32 v67, v67, v4
    v_mul_f32 v68, v68, v4
    v_mul_f32 v69, v69, v4
    v_mul_f32 v70, v70, v4
    v_mul_f32 v71, v71, v4
    v_mul_f32 v72, v72, v4
    v_mul_f32 v73, v73, v4
    v_mul_f32 v74, v74, v4
    v_mul_f32 v75, v75, v4
    v_mul_f32 v76, v76, v4
    v_mul_f32 v77, v77, v4
    v_mul_f32 v78, v78, v4
    v_mul_f32 v79, v79, v4
    v_mul_f32 v80, v80, v4
    v_mul_f32 v81, v81, v4
    v_mul_f32 v82, v82, v4
    v_mul_f32 v83, v83, v4
    v_cvt_pk_bf16_f32 v24, v64, v65
    v_cvt_pk_bf16_f32 v25, v66, v67
    v_cvt_pk_bf16_f32 v26, v68, v69
    v_cvt_pk_bf16_f32 v27, v70, v71
    v_cvt_pk_bf16_f32 v28, v72, v73
    v_cvt_pk_bf16_f32 v29, v74, v75
    v_cvt_pk_bf16_f32 v30, v76, v77
    v_cvt_pk_bf16_f32 v31, v78, v79
    v_cvt_pk_bf16_f32 v32, v80, v81
    v_cvt_pk_bf16_f32 v33, v82, v83
    buffer_store_dwordx4 v[24:27], v2, s[16:19], s71 offen sc1
    buffer_store_dwordx2 v[28:29], v3, s[16:19], s71 offen sc1
    s_add_u32 s71, s71, 81920
    buffer_store_dwordx4 v[30:33], v2, s[16:19], s71 offen sc1
    s_add_u32 s71, s71, 81920
    v_mul_f32 v84, v84, v4
    v_mul_f32 v85, v85, v4
    v_mul_f32 v86, v86, v4
    v_mul_f32 v87, v87, v4
    v_mul_f32 v88, v88, v4
    v_mul_f32 v89, v89, v4
    v_mul_f32 v90, v90, v4
    v_mul_f32 v91, v91, v4
    v_mul_f32 v92, v92, v4
    v_mul_f32 v93, v93, v4
    v_mul_f32 v94, v94, v4
    v_mul_f32 v95, v95, v4
    v_mul_f32 v96, v96, v4
    v_mul_f32 v97, v97, v4
    v_mul_f32 v98, v98, v4
    v_mul_f32 v99, v99, v4
    v_mul_f32 v100, v100, v4
    v_mul_f32 v101, v101, v4
    v_mul_f32 v102, v102, v4
    v_mul_f32 v103, v103, v4
    v_cvt_pk_bf16_f32 v34, v84, v85
    v_cvt_pk_bf16_f32 v35, v86, v87
    v_cvt_pk_bf16_f32 v36, v88, v89
    v_cvt_pk_bf16_f32 v37, v90, v91
    v_cvt_pk_bf16_f32 v38, v92, v93
    v_cvt_pk_bf16_f32 v39, v94, v95
    v_cvt_pk_bf16_f32 v40, v96, v97
    v_cvt_pk_bf16_f32 v41, v98, v99
    v_cvt_pk_bf16_f32 v42, v100, v101
    v_cvt_pk_bf16_f32 v43, v102, v103
    buffer_store_dwordx4 v[34:37], v2, s[16:19], s71 offen sc1
    buffer_store_dwordx2 v[38:39], v3, s[16:19], s71 offen sc1
    s_add_u32 s71, s71, 81920
    buffer_store_dwordx4 v[40:43], v2, s[16:19], s71 offen sc1
    s_add_u32 s71, s71, 81920
    v_mul_f32 v104, v104, v4
    v_mul_f32 v105, v105, v4
    v_mul_f32 v106, v106, v4
    v_mul_f32 v107, v107, v4
    v_mul_f32 v108, v108, v4
    v_mul_f32 v109, v109, v4
    v_mul_f32 v110, v110, v4
    v_mul_f32 v111, v111, v4
    v_mul_f32 v112, v112, v4
    v_mul_f32 v113, v113, v4
    v_mul_f32 v114, v114, v4
    v_mul_f32 v115, v115, v4
    v_mul_f32 v116, v116, v4
    v_mul_f32 v117, v117, v4
    v_mul_f32 v118, v118, v4
    v_mul_f32 v119, v119, v4
    v_mul_f32 v120, v120, v4
    v_mul_f32 v121, v121, v4
    v_mul_f32 v122, v122, v4
    v_mul_f32 v123, v123, v4
    v_cvt_pk_bf16_f32 v44, v104, v105
    v_cvt_pk_bf16_f32 v45, v106, v107
    v_cvt_pk_bf16_f32 v46, v108, v109
    v_cvt_pk_bf16_f32 v47, v110, v111
    v_cvt_pk_bf16_f32 v48, v112, v113
    v_cvt_pk_bf16_f32 v49, v114, v115
    v_cvt_pk_bf16_f32 v50, v116, v117
    v_cvt_pk_bf16_f32 v51, v118, v119
    v_cvt_pk_bf16_f32 v52, v120, v121
    v_cvt_pk_bf16_f32 v53, v122, v123
    buffer_store_dwordx4 v[44:47], v2, s[16:19], s71 offen sc1
    buffer_store_dwordx2 v[48:49], v3, s[16:19], s71 offen sc1
    s_add_u32 s71, s71, 81920
    buffer_store_dwordx4 v[50:53], v2, s[16:19], s71 offen sc1
    s_add_u32 s71, s71, 81920
    v_mul_f32 v124, v124, v4
    v_mul_f32 v125, v125, v4
    v_mul_f32 v126, v126, v4
    v_mul_f32 v127, v127, v4
    v_mul_f32 v128, v128, v4
    v_mul_f32 v129, v129, v4
    v_mul_f32 v130, v130, v4
    v_mul_f32 v131, v131, v4
    v_mul_f32 v132, v132, v4
    v_mul_f32 v133, v133, v4
    v_mul_f32 v134, v134, v4
    v_mul_f32 v135, v135, v4
    v_mul_f32 v136, v136, v4
    v_mul_f32 v137, v137, v4
    v_mul_f32 v138, v138, v4
    v_mul_f32 v139, v139, v4
    v_mul_f32 v140, v140, v4
    v_mul_f32 v141, v141, v4
    v_mul_f32 v142, v142, v4
    v_mul_f32 v143, v143, v4
    v_cvt_pk_bf16_f32 v54, v124, v125
    v_cvt_pk_bf16_f32 v55, v126, v127
    v_cvt_pk_bf16_f32 v56, v128, v129
    v_cvt_pk_bf16_f32 v57, v130, v131
    v_cvt_pk_bf16_f32 v58, v132, v133
    v_cvt_pk_bf16_f32 v59, v134, v135
    v_cvt_pk_bf16_f32 v60, v136, v137
    v_cvt_pk_bf16_f32 v61, v138, v139
    v_cvt_pk_bf16_f32 v62, v140, v141
    v_cvt_pk_bf16_f32 v63, v142, v143
    buffer_store_dwordx4 v[54:57], v2, s[16:19], s71 offen sc1
    buffer_store_dwordx2 v[58:59], v3, s[16:19], s71 offen sc1
    s_add_u32 s71, s71, 81920
    buffer_store_dwordx4 v[60:63], v2, s[16:19], s71 offen sc1
    s_add_u32 s71, s71, 81920
    s_endpgm
LGV:
    s_mul_i32 s58, s28, 320
    s_lshr_b32 s59, s24, 1
    s_mul_i32 s59, s59, 2592
    s_and_b32 s57, s24, 1
    s_mul_i32 s57, s57, 1280
    s_add_u32 s59, s59, s57
    s_mul_i32 s60, s24, 80
    s_lshl_b32 s56, s24, 12
    s_add_u32 s59, s59, 98304
    s_mov_b32 s62, 3840
    v_add_u32 v6, s56, v6
    v_add_u32 v7, s56, v7
    v_add_u32 v8, s56, v8
    v_add_u32 v9, s56, v9
    v_add_u32 v24, s60, v1
    v_add_u32 v24, 0, v24
    v_mul_u32_u24 v25, 52429, v24
    v_lshrrev_b32 v25, 20, v25
    v_mul_u32_u24 v26, 20, v25
    v_sub_u32 v26, v24, v26
    v_mul_lo_u32 v25, v25, s62
    v_lshl_add_u32 v25, v26, 4, v25
    v_add_u32 v14, s58, v25
    v_add_u32 v24, s60, v1
    v_add_u32 v24, 64, v24
    v_mul_u32_u24 v25, 52429, v24
    v_lshrrev_b32 v25, 20, v25
    v_mul_u32_u24 v26, 20, v25
    v_sub_u32 v26, v24, v26
    v_mul_lo_u32 v25, v25, s62
    v_lshl_add_u32 v25, v26, 4, v25
    v_add_u32 v15, s58, v25
    v_subrev_u32 v15, 1024, v15
    s_mov_b32 s64, 0xffff
    s_mov_b32 s65, 0
    s_mov_b32 s30, 0
    s_mov_b32 s31, 0
    s_mov_b32 s32, 0
    s_mov_b32 s33, 0
    s_mov_b32 s66, 0
    s_mov_b32 s67, 0
    s_waitcnt lgkmcnt(0)
    s_mov_b32 s8, s36
    s_mov_b32 s9, s37
    s_mov_b32 s10, 2621440
    s_mov_b32 s11, 0x00020000
    s_mov_b32 s12, s38
    s_mov_b32 s13, s39
    s_mov_b32 s14, 2457600
    s_mov_b32 s15, 0x00020000
    s_add_u32 m0, s59, s33
    s_nop 0
    buffer_load_dwordx4 v14, s[12:15], s31 offen lds
    s_add_u32 m0, s63, s32
    s_nop 0
    buffer_load_dwordx4 v10, s[8:11], s30 offen offset:0 lds
    s_add_u32 m0, s59, s33
    s_mov_b64 exec, s[64:65]
    buffer_load_dwordx4 v15, s[12:15], s31 offen offset:1024 lds
    s_mov_b64 exec, -1
    s_add_u32 s33, s33, 12576
    s_cmp_eq_u32 s33, 62880
    s_cselect_b32 s33, 0, s33
    s_add_u32 s31, s31, 122880
    s_add_u32 m0, s63, s32
    s_nop 0
    buffer_load_dwordx4 v11, s[8:11], s30 offen offset:1024 lds
    s_add_u32 m0, s59, s33
    s_nop 0
    buffer_load_dwordx4 v14, s[12:15], s31 offen lds
    s_add_u32 m0, s63, s32
    s_nop 0
    buffer_load_dwordx4 v12, s[8:11], s30 offen offset:2048 lds
    s_add_u32 m0, s59, s33
    s_mov_b64 exec, s[64:65]
    buffer_load_dwordx4 v15, s[12:15], s31 offen offset:1024 lds
    s_mov_b64 exec, -1
    s_add_u32 s33, s33, 12576
    s_cmp_eq_u32 s33, 62880
    s_cselect_b32 s33, 0, s33
    s_add_u32 s31, s31, 122880
    s_add_u32 m0, s63, s32
    s_nop 0
    buffer_load_dwordx4 v13, s[8:11], s30 offen offset:3072 lds
    s_add_u32 s32, s32, 32768
    s_cmp_eq_u32 s32, 98304
    s_cselect_b32 s32, 0, s32
    s_add_u32 s30, s30, 128
    s_add_u32 m0, s59, s33
    s_nop 0
    buffer_load_dwordx4 v14, s[12:15], s31 offen lds
    s_add_u32 m0, s63, s32
    s_nop 0
    buffer_load_dwordx4 v10, s[8:11], s30 offen offset:0 lds
    s_add_u32 m0, s59, s33
    s_mov_b64 exec, s[64:65]
    buffer_load_dwordx4 v15, s[12:15], s31 offen offset:1024 lds
    s_mov_b64 exec, -1
    s_add_u32 s33, s33, 12576
    s_cmp_eq_u32 s33, 62880
    s_cselect_b32 s33, 0, s33
    s_add_u32 s31, s31, 122880
    s_add_u32 m0, s63, s32
    s_nop 0
    buffer_load_dwordx4 v11, s[8:11], s30 offen offset:1024 lds
    s_add_u32 m0, s59, s33
    s_nop 0
    buffer_load_dwordx4 v14, s[12:15], s31 offen lds
    s_add_u32 m0, s63, s32
    s_nop 0
    buffer_load_dwordx4 v12, s[8:11], s30 offen offset:2048 lds
    s_add_u32 m0, s59, s33
    s_mov_b64 exec, s[64:65]
    buffer_load_dwordx4 v15, s[12:15], s31 offen offset:1024 lds
    s_mov_b64 exec, -1
    s_add_u32 s33, s33, 12576
    s_cmp_eq_u32 s33, 62880
    s_cselect_b32 s33, 0, s33
    s_add_u32 s31, s31, 122880
    s_add_u32 m0, s63, s32
    s_nop 0
    buffer_load_dwordx4 v13, s[8:11], s30 offen offset:3072 lds
    s_add_u32 s32, s32, 32768
    s_cmp_eq_u32 s32, 98304
    s_cselect_b32 s32, 0, s32
    s_add_u32 s30, s30, 128
    s_mov_b32 s16, s54
    s_mov_b32 s17, s55
    s_mov_b32 s18, 268435456
    s_mov_b32 s19, 0x00020000
    s_mov_b32 s20, s52
    s_mov_b32 s21, s53
    s_mov_b32 s22, 256
    s_mov_b32 s23, 0x00020000
    v_bfe_u32 v26, v1, 2, 2
    v_mul_u32_u24 v26, 320, v26
    v_and_b32 v27, 3, v1
    v_lshl_add_u32 v26, v27, 3, v26
    v_lshrrev_b32 v24, 5, v1
    v_mul_u32_u24 v24, 2592, v24
    v_bfe_u32 v27, v1, 4, 1
    v_mul_u32_u24 v27, 32, v27
    v_add3_u32 v16, v24, v26, v27
    s_mov_b32 s61, 98304
    v_add_u32 v16, s61, v16
    v_mov_b32 v64, 0
    v_mov_b32 v65, 0
    v_mov_b32 v66, 0
    v_mov_b32 v67, 0
    v_mov_b32 v68, 0
    v_mov_b32 v69, 0
    v_mov_b32 v70, 0
    v_mov_b32 v71, 0
    v_mov_b32 v72, 0
    v_mov_b32 v73, 0
    v_mov_b32 v74, 0
    v_mov_b32 v75, 0
    v_mov_b32 v76, 0
    v_mov_b32 v77, 0
    v_mov_b32 v78, 0
    v_mov_b32 v79, 0
    v_mov_b32 v80, 0
    v_mov_b32 v81, 0
    v_mov_b32 v82, 0
    v_mov_b32 v83, 0
    v_mov_b32 v84, 0
    v_mov_b32 v85, 0
    v_mov_b32 v86, 0
    v_mov_b32 v87, 0
    v_mov_b32 v88, 0
    v_mov_b32 v89, 0
    v_mov_b32 v90, 0
    v_mov_b32 v91, 0
    v_mov_b32 v92, 0
    v_mov_b32 v93, 0
    v_mov_b32 v94, 0
    v_mov_b32 v95, 0
    v_mov_b32 v96, 0
    v_mov_b32 v97, 0
    v_mov_b32 v98, 0
    v_mov_b32 v99, 0
    v_mov_b32 v100, 0
    v_mov_b32 v101, 0
    v_mov_b32 v102, 0
    v_mov_b32 v103, 0
    v_mov_b32 v104, 0
    v_mov_b32 v105, 0
    v_mov_b32 v106, 0
    v_mov_b32 v107, 0
    v_mov_b32 v108, 0
    v_mov_b32 v109, 0
    v_mov_b32 v110, 0
    v_mov_b32 v111, 0
    v_mov_b32 v112, 0
    v_mov_b32 v113, 0
    v_mov_b32 v114, 0
    v_mov_b32 v115, 0
    v_mov_b32 v116, 0
    v_mov_b32 v117, 0
    v_mov_b32 v118, 0
    v_mov_b32 v119, 0
    v_mov_b32 v120, 0
    v_mov_b32 v121, 0
    v_mov_b32 v122, 0
    v_mov_b32 v123, 0
    v_mov_b32 v124, 0
    v_mov_b32 v125, 0
    v_mov_b32 v126, 0
    v_mov_b32 v127, 0
    v_mov_b32 v128, 0
    v_mov_b32 v129, 0
    v_mov_b32 v130, 0
    v_mov_b32 v131, 0
    v_mov_b32 v132, 0
    v_mov_b32 v133, 0
    v_mov_b32 v134, 0
    v_mov_b32 v135, 0
    v_mov_b32 v136, 0
    v_mov_b32 v137, 0
    v_mov_b32 v138, 0
    v_mov_b32 v139, 0
    v_mov_b32 v140, 0
    v_mov_b32 v141, 0
    v_mov_b32 v142, 0
    v_mov_b32 v143, 0
    s_waitcnt vmcnt(8) lgkmcnt(0)
    s_barrier
    ds_read_b128 v[168:171], v6 offset:0
    ds_read_b64_tr_b16 v[172:173], v16 offset:0
    ds_read_b64_tr_b16 v[174:175], v16 offset:1280
    ds_read_b64_tr_b16 v[176:177], v16 offset:64
    ds_read_b64_tr_b16 v[178:179], v16 offset:1344
    ds_read_b64_tr_b16 v[180:181], v16 offset:128
    ds_read_b64_tr_b16 v[182:183], v16 offset:1408
    ds_read_b64_tr_b16 v[184:185], v16 offset:192
    ds_read_b64_tr_b16 v[186:187], v16 offset:1472
    ds_read_b64_tr_b16 v[188:189], v16 offset:256
    ds_read_b64_tr_b16 v[190:191], v16 offset:1536
    s_add_u32 s69, s66, 32768
    s_cmp_eq_u32 s69, 98304
    s_cselect_b32 s69, 0, s69
    s_sub_u32 s68, s69, s66
    s_mov_b32 s66, s69
    v_add_u32 v6, s68, v6
    s_mov_b32 s34, 8
    s_branch LGV_in
.p2align 6
LGV_loop:
    s_waitcnt vmcnt(9)
    s_barrier
LGV_in:
    s_waitcnt lgkmcnt(0)
    v_mfma_f32_32x32x16_bf16 v[64:79], v[168:171], v[172:175], v[64:79]
    ds_read_b128 v[192:195], v7 offset:0
    v_add_u32 v7, s68, v7
    ds_read_b64_tr_b16 v[196:197], v16 offset:5184
    ds_read_b64_tr_b16 v[198:199], v16 offset:6464
    ds_read_b64_tr_b16 v[200:201], v16 offset:5248
    v_mfma_f32_32x32x16_bf16 v[80:95], v[168:171], v[176:179], v[80:95]
    ds_read_b64_tr_b16 v[202:203], v16 offset:6528
    ds_read_b64_tr_b16 v[204:205], v16 offset:5312
    ds_read_b64_tr_b16 v[206:207], v16 offset:6592
    ds_read_b64_tr_b16 v[208:209], v16 offset:5376
    s_add_u32 m0, s59, s33
    s_nop 0
    buffer_load_dwordx4 v14, s[12:15], s31 offen lds
    v_mfma_f32_32x32x16_bf16 v[96:111], v[168:171], v[180:183], v[96:111]
    ds_read_b64_tr_b16 v[210:211], v16 offset:6656
    ds_read_b64_tr_b16 v[212:213], v16 offset:5440
    ds_read_b64_tr_b16 v[214:215], v16 offset:6720
    v_mfma_f32_32x32x16_bf16 v[112:127], v[168:171], v[184:187], v[112:127]
    s_add_u32 m0, s63, s32
    s_nop 0
    buffer_load_dwordx4 v10, s[8:11], s30 offen offset:0 lds
    v_mfma_f32_32x32x16_bf16 v[128:143], v[168:171], v[188:191], v[128:143]
    s_waitcnt lgkmcnt(0)
    s_add_u32 s69, s67, 12576
    s_cmp_eq_u32 s69, 62880
    s_cselect_b32 s69, 0, s69
    s_sub_u32 s70, s69, s67
    s_mov_b32 s67, s69
    v_add_u32 v16, s70, v16
    v_mfma_f32_32x32x16_bf16 v[64:79], v[192:195], v[196:199], v[64:79]
    ds_read_b128 v[168:171], v8 offset:0
    v_add_u32 v8, s68, v8
    ds_read_b64_tr_b16 v[172:173], v16 offset:0
    ds_read_b64_tr_b16 v[174:175], v16 offset:1280
    ds_read_b64_tr_b16 v[176:177], v16 offset:64
    v_mfma_f32_32x32x16_bf16 v[80:95], v[192:195], v[200:203], v[80:95]
    ds_read_b64_tr_b16 v[178:179], v16 offset:1344
    ds_read_b64_tr_b16 v[180:181], v16 offset:128
    ds_read_b64_tr_b16 v[182:183], v16 offset:1408
    ds_read_b64_tr_b16 v[184:185], v16 offset:192
    s_add_u32 m0, s59, s33
    s_mov_b64 exec, s[64:65]
    buffer_load_dwordx4 v15, s[12:15], s31 offen offset:1024 lds
    s_mov_b64 exec, -1
    s_add_u32 s33, s33, 12576
    s_cmp_eq_u32 s33, 62880
    s_cselect_b32 s33, 0, s33
    s_add_u32 s31, s31, 122880
    v_mfma_f32_32x32x16_bf16 v[96:111], v[192:195], v[204:207], v[96:111]
    ds_read_b64_tr_b16 v[186:187], v16 offset:1472
    ds_read_b64_tr_b16 v[188:189], v16 offset:256
    ds_read_b64_tr_b16 v[190:191], v16 offset:1536
    v_mfma_f32_32x32x16_bf16 v[112:127], v[192:195], v[208:211], v[112:127]
    s_add_u32 m0, s63, s32
    s_nop 0
    buffer_load_dwordx4 v11, s[8:11], s30 offen offset:1024 lds
    v_mfma_f32_32x32x16_bf16 v[128:143], v[192:195], v[212:215], v[128:143]
    s_waitcnt vmcnt(9)
    s_barrier
    s_waitcnt lgkmcnt(0)
    v_mfma_f32_32x32x16_bf16 v[64:79], v[168:171], v[172:175], v[64:79]
    ds_read_b128 v[192:195], v9 offset:0
    v_add_u32 v9, s68, v9
    ds_read_b64_tr_b16 v[196:197], v16 offset:5184
    ds_read_b64_tr_b16 v[198:199], v16 offset:6464
    ds_read_b64_tr_b16 v[200:201], v16 offset:5248
    v_mfma_f32_32x32x16_bf16 v[80:95], v[168:171], v[176:179], v[80:95]
    ds_read_b64_tr_b16 v[202:203], v16 offset:6528
    ds_read_b64_tr_b16 v[204:205], v16 offset:5312
    ds_read_b64_tr_b16 v[206:207], v16 offset:6592
    ds_read_b64_tr_b16 v[208:209], v16 offset:5376
    s_add_u32 m0, s59, s33
    s_nop 0
    buffer_load_dwordx4 v14, s[12:15], s31 offen lds
    v_mfma_f32_32x32x16_bf16 v[96:111], v[168:171], v[180:183], v[96:111]
    ds_read_b64_tr_b16 v[210:211], v16 offset:6656
    ds_read_b64_tr_b16 v[212:213], v16 offset:5440
    ds_read_b64_tr_b16 v[214:215], v16 offset:6720
    v_mfma_f32_32x32x16_bf16 v[112:127], v[168:171], v[184:187], v[112:127]
    s_add_u32 m0, s63, s32
    s_nop 0
    buffer_load_dwordx4 v12, s[8:11], s30 offen offset:2048 lds
    v_mfma_f32_32x32x16_bf16 v[128:143], v[168:171], v[188:191], v[128:143]
    s_waitcnt vmcnt(6) lgkmcnt(0)
    s_add_u32 s69, s67, 12576
    s_cmp_eq_u32 s69, 62880
    s_cselect_b32 s69, 0, s69
    s_sub_u32 s70, s69, s67
    s_mov_b32 s67, s69
    v_add_u32 v16, s70, v16
    v_mfma_f32_32x32x16_bf16 v[64:79], v[192:195], v[196:199], v[64:79]
    ds_read_b128 v[168:171], v6 offset:0
    s_add_u32 s69, s66, 32768
    s_cmp_eq_u32 s69, 98304
    s_cselect_b32 s69, 0, s69
    s_sub_u32 s68, s69, s66
    s_mov_b32 s66, s69
    v_add_u32 v6, s68, v6
    ds_read_b64_tr_b16 v[172:173], v16 offset:0
    ds_read_b64_tr_b16 v[174:175], v16 offset:1280
    ds_read_b64_tr_b16 v[176:177], v16 offset:64
    v_mfma_f32_32x32x16_bf16 v[80:95], v[192:195], v[200:203], v[80:95]
    ds_read_b64_tr_b16 v[178:179], v16 offset:1344
    ds_read_b64_tr_b16 v[180:181], v16 offset:128
    ds_read_b64_tr_b16 v[182:183], v16 offset:1408
    ds_read_b64_tr_b16 v[184:185], v16 offset:192
    s_add_u32 m0, s59, s33
    s_mov_b64 exec, s[64:65]
    buffer_load_dwordx4 v15, s[12:15], s31 offen offset:1024 lds
    s_mov_b64 exec, -1
    s_add_u32 s33, s33, 12576
    s_cmp_eq_u32 s33, 62880
    s_cselect_b32 s33, 0, s33
    s_add_u32 s31, s31, 122880
    v_mfma_f32_32x32x16_bf16 v[96:111], v[192:195], v[204:207], v[96:111]
    ds_read_b64_tr_b16 v[186:187], v16 offset:1472
    ds_read_b64_tr_b16 v[188:189], v16 offset:256
    ds_read_b64_tr_b16 v[190:191], v16 offset:1536
    v_mfma_f32_32x32x16_bf16 v[112:127], v[192:195], v[208:211], v[112:127]
    s_add_u32 m0, s63, s32
    s_nop 0
    buffer_load_dwordx4 v13, s[8:11], s30 offen offset:3072 lds
    s_add_u32 s32, s32, 32768
    s_cmp_eq_u32 s32, 98304
    s_cselect_b32 s32, 0, s32
    s_add_u32 s30, s30, 128
    v_mfma_f32_32x32x16_bf16 v[128:143], v[192:195], v[212:215], v[128:143]
    s_sub_u32 s34, s34, 1
    s_cmp_lg_u32 s34, 0
    s_cbranch_scc1 LGV_loop
    s_waitcnt vmcnt(9)
    s_barrier
    s_waitcnt lgkmcnt(0)
    v_mfma_f32_32x32x16_bf16 v[64:79], v[168:171], v[172:175], v[64:79]
    ds_read_b128 v[192:195], v7 offset:0
    v_add_u32 v7, s68, v7
    ds_read_b64_tr_b16 v[196:197], v16 offset:5184
    ds_read_b64_tr_b16 v[198:199], v16 offset:6464
    ds_read_b64_tr_b16 v[200:201], v16 offset:5248
    v_mfma_f32_32x32x16_bf16 v[80:95], v[168:171], v[176:179], v[80:95]
    ds_read_b64_tr_b16 v[202:203], v16 offset:6528
    ds_read_b64_tr_b16 v[204:205], v16 offset:5312
    ds_read_b64_tr_b16 v[206:207], v16 offset:6592
    ds_read_b64_tr_b16 v[208:209], v16 offset:5376
    v_mfma_f32_32x32x16_bf16 v[96:111], v[168:171], v[180:183], v[96:111]
    ds_read_b64_tr_b16 v[210:211], v16 offset:6656
    ds_read_b64_tr_b16 v[212:213], v16 offset:5440
    ds_read_b64_tr_b16 v[214:215], v16 offset:6720
    v_mfma_f32_32x32x16_bf16 v[112:127], v[168:171], v[184:187], v[112:127]
    v_mfma_f32_32x32x16_bf16 v[128:143], v[168:171], v[188:191], v[128:143]
    s_waitcnt lgkmcnt(0)
    s_add_u32 s69, s67, 12576
    s_cmp_eq_u32 s69, 62880
    s_cselect_b32 s69, 0, s69
    s_sub_u32 s70, s69, s67
    s_mov_b32 s67, s69
    v_add_u32 v16, s70, v16
    v_mfma_f32_32x32x16_bf16 v[64:79], v[192:195], v[196:199], v[64:79]
    ds_read_b128 v[168:171], v8 offset:0
    v_add_u32 v8, s68, v8
    ds_read_b64_tr_b16 v[172:173], v16 offset:0
    ds_read_b64_tr_b16 v[174:175], v16 offset:1280
    ds_read_b64_tr_b16 v[176:177], v16 offset:64
    v_mfma_f32_32x32x16_bf16 v[80:95], v[192:195], v[200:203], v[80:95]
    ds_read_b64_tr_b16 v[178:179], v16 offset:1344
    ds_read_b64_tr_b16 v[180:181], v16 offset:128
    ds_read_b64_tr_b16 v[182:183], v16 offset:1408
    ds_read_b64_tr_b16 v[184:185], v16 offset:192
    v_mfma_f32_32x32x16_bf16 v[96:111], v[192:195], v[204:207], v[96:111]
    ds_read_b64_tr_b16 v[186:187], v16 offset:1472
    ds_read_b64_tr_b16 v[188:189], v16 offset:256
    ds_read_b64_tr_b16 v[190:191], v16 offset:1536
    v_mfma_f32_32x32x16_bf16 v[112:127], v[192:195], v[208:211], v[112:127]
    v_mfma_f32_32x32x16_bf16 v[128:143], v[192:195], v[212:215], v[128:143]
    s_waitcnt vmcnt(5)
    s_barrier
    s_waitcnt lgkmcnt(0)
    v_mfma_f32_32x32x16_bf16 v[64:79], v[168:171], v[172:175], v[64:79]
    ds_read_b128 v[192:195], v9 offset:0
    v_add_u32 v9, s68, v9
    ds_read_b64_tr_b16 v[196:197], v16 offset:5184
    ds_read_b64_tr_b16 v[198:199], v16 offset:6464
    ds_read_b64_tr_b16 v[200:201], v16 offset:5248
    v_mfma_f32_32x32x16_bf16 v[80:95], v[168:171], v[176:179], v[80:95]
    ds_read_b64_tr_b16 v[202:203], v16 offset:6528
    ds_read_b64_tr_b16 v[204:205], v16 offset:5312
    ds_read_b64_tr_b16 v[206:207], v16 offset:6592
    ds_read_b64_tr_b16 v[208:209], v16 offset:5376
    v_mfma_f32_32x32x16_bf16 v[96:111], v[168:171], v[180:183], v[96:111]
    ds_read_b64_tr_b16 v[210:211], v16 offset:6656
    ds_read_b64_tr_b16 v[212:213], v16 offset:5440
    ds_read_b64_tr_b16 v[214:215], v16 offset:6720
    v_mfma_f32_32x32x16_bf16 v[112:127], v[168:171], v[184:187], v[112:127]
    v_mfma_f32_32x32x16_bf16 v[128:143], v[168:171], v[188:191], v[128:143]
    s_waitcnt vmcnt(0) lgkmcnt(0)
    s_add_u32 s69, s67, 12576
    s_cmp_eq_u32 s69, 62880
    s_cselect_b32 s69, 0, s69
    s_sub_u32 s70, s69, s67
    s_mov_b32 s67, s69
    v_add_u32 v16, s70, v16
    v_mfma_f32_32x32x16_bf16 v[64:79], v[192:195], v[196:199], v[64:79]
    ds_read_b128 v[168:171], v6 offset:0
    s_add_u32 s69, s66, 32768
    s_cmp_eq_u32 s69, 98304
    s_cselect_b32 s69, 0, s69
    s_sub_u32 s68, s69, s66
    s_mov_b32 s66, s69
    v_add_u32 v6, s68, v6
    ds_read_b64_tr_b16 v[172:173], v16 offset:0
    ds_read_b64_tr_b16 v[174:175], v16 offset:1280
    ds_read_b64_tr_b16 v[176:177], v16 offset:64
    v_mfma_f32_32x32x16_bf16 v[80:95], v[192:195], v[200:203], v[80:95]
    ds_read_b64_tr_b16 v[178:179], v16 offset:1344
    ds_read_b64_tr_b16 v[180:181], v16 offset:128
    ds_read_b64_tr_b16 v[182:183], v16 offset:1408
    ds_read_b64_tr_b16 v[184:185], v16 offset:192
    v_mfma_f32_32x32x16_bf16 v[96:111], v[192:195], v[204:207], v[96:111]
    ds_read_b64_tr_b16 v[186:187], v16 offset:1472
    ds_read_b64_tr_b16 v[188:189], v16 offset:256
    ds_read_b64_tr_b16 v[190:191], v16 offset:1536
    v_mfma_f32_32x32x16_bf16 v[112:127], v[192:195], v[208:211], v[112:127]
    v_mfma_f32_32x32x16_bf16 v[128:143], v[192:195], v[212:215], v[128:143]
    s_waitcnt vmcnt(0)
    s_barrier
    buffer_load_dword v24, v5, s[20:23], 0 offen sc1
    s_waitcnt lgkmcnt(0)
    v_mfma_f32_32x32x16_bf16 v[64:79], v[168:171], v[172:175], v[64:79]
    ds_read_b128 v[192:195], v7 offset:0
    v_add_u32 v7, s68, v7
    ds_read_b64_tr_b16 v[196:197], v16 offset:5184
    ds_read_b64_tr_b16 v[198:199], v16 offset:6464
    ds_read_b64_tr_b16 v[200:201], v16 offset:5248
    v_mfma_f32_32x32x16_bf16 v[80:95], v[168:171], v[176:179], v[80:95]
    ds_read_b64_tr_b16 v[202:203], v16 offset:6528
    ds_read_b64_tr_b16 v[204:205], v16 offset:5312
    ds_read_b64_tr_b16 v[206:207], v16 offset:6592
    ds_read_b64_tr_b16 v[208:209], v16 offset:5376
    v_mfma_f32_32x32x16_bf16 v[96:111], v[168:171], v[180:183], v[96:111]
    ds_read_b64_tr_b16 v[210:211], v16 offset:6656
    ds_read_b64_tr_b16 v[212:213], v16 offset:5440
    ds_read_b64_tr_b16 v[214:215], v16 offset:6720
    v_mfma_f32_32x32x16_bf16 v[112:127], v[168:171], v[184:187], v[112:127]
    v_mfma_f32_32x32x16_bf16 v[128:143], v[168:171], v[188:191], v[128:143]
    s_waitcnt vmcnt(0)
    v_cmp_eq_u32 vcc, 0, v24
    s_mov_b32 s78, 0
    s_nop 3
    s_cmp_eq_u64 vcc, 0
    s_cbranch_scc0 LGV_notyet
    s_mov_b32 s78, 1
    s_mov_b32 s76, s29
    v_and_b32 v25, 31, v1
    v_add_u32 v26, s76, v25
    v_lshlrev_b32 v26, 2, v26
    s_mov_b32 s69, 19922944
    s_mov_b32 s70, 19931136
    buffer_load_dword v28, v26, s[16:19], s69 offen offset:0 sc1
    v_lshrrev_b32 v27, 5, v1
    v_lshlrev_b32 v27, 2, v27
    v_add_u32 v27, s76, v27
    v_lshlrev_b32 v27, 2, v27
    buffer_load_dwordx4 v[40:43], v27, s[16:19], s70 offen offset:0 sc1
    buffer_load_dwordx4 v[44:47], v27, s[16:19], s70 offen offset:32 sc1
    buffer_load_dwordx4 v[48:51], v27, s[16:19], s70 offen offset:64 sc1
    buffer_load_dwordx4 v[52:55], v27, s[16:19], s70 offen offset:96 sc1
    v_lshlrev_b32 v32, 2, v25
    s_mul_i32 s69, s28, 640
    s_add_u32 s69, s69, 19939328
    buffer_load_dword v228, v32, s[16:19], s69 offen offset:0 sc1
    buffer_load_dword v229, v32, s[16:19], s69 offen offset:128 sc1
    buffer_load_dword v230, v32, s[16:19], s69 offen offset:256 sc1
    buffer_load_dword v231, v32, s[16:19], s69 offen offset:384 sc1
    buffer_load_dword v232, v32, s[16:19], s69 offen offset:512 sc1
    s_add_u32 s69, s69, 19968
    buffer_load_dword v233, v32, s[16:19], s69 offen offset:0 sc1
    buffer_load_dword v234, v32, s[16:19], s69 offen offset:128 sc1
    buffer_load_dword v235, v32, s[16:19], s69 offen offset:256 sc1
    buffer_load_dword v236, v32, s[16:19], s69 offen offset:384 sc1
    buffer_load_dword v237, v32, s[16:19], s69 offen offset:512 sc1
    s_add_u32 s69, s69, 19968
    buffer_load_dword v238, v32, s[16:19], s69 offen offset:0 sc1
    buffer_load_dword v239, v32, s[16:19], s69 offen offset:128 sc1
    buffer_load_dword v240, v32, s[16:19], s69 offen offset:256 sc1
    buffer_load_dword v241, v32, s[16:19], s69 offen offset:384 sc1
    buffer_load_dword v242, v32, s[16:19], s69 offen offset:512 sc1
    s_add_u32 s69, s69, 19968
    buffer_load_dword v243, v32, s[16:19], s69 offen offset:0 sc1
    buffer_load_dword v244, v32, s[16:19], s69 offen offset:128 sc1
    buffer_load_dword v245, v32, s[16:19], s69 offen offset:256 sc1
    buffer_load_dword v246, v32, s[16:19], s69 offen offset:384 sc1
    buffer_load_dword v247, v32, s[16:19], s69 offen offset:512 sc1
LGV_notyet:
    s_waitcnt lgkmcnt(0)
    s_add_u32 s69, s67, 12576
    s_cmp_eq_u32 s69, 62880
    s_cselect_b32 s69, 0, s69
    s_sub_u32 s70, s69, s67
    s_mov_b32 s67, s69
    v_add_u32 v16, s70, v16
    v_mfma_f32_32x32x16_bf16 v[64:79], v[192:195], v[196:199], v[64:79]
    ds_read_b128 v[168:171], v8 offset:0
    v_add_u32 v8, s68, v8
    ds_read_b64_tr_b16 v[172:173], v16 offset:0
    ds_read_b64_tr_b16 v[174:175], v16 offset:1280
    ds_read_b64_tr_b16 v[176:177], v16 offset:64
    v_mfma_f32_32x32x16_bf16 v[80:95], v[192:195], v[200:203], v[80:95]
    ds_read_b64_tr_b16 v[178:179], v16 offset:1344
    ds_read_b64_tr_b16 v[180:181], v16 offset:128
    ds_read_b64_tr_b16 v[182:183], v16 offset:1408
    ds_read_b64_tr_b16 v[184:185], v16 offset:192
    v_mfma_f32_32x32x16_bf16 v[96:111], v[192:195], v[204:207], v[96:111]
    ds_read_b64_tr_b16 v[186:187], v16 offset:1472
    ds_read_b64_tr_b16 v[188:189], v16 offset:256
    ds_read_b64_tr_b16 v[190:191], v16 offset:1536
    v_mfma_f32_32x32x16_bf16 v[112:127], v[192:195], v[208:211], v[112:127]
    v_mfma_f32_32x32x16_bf16 v[128:143], v[192:195], v[212:215], v[128:143]
    s_waitcnt lgkmcnt(0)
    v_mfma_f32_32x32x16_bf16 v[64:79], v[168:171], v[172:175], v[64:79]
    ds_read_b128 v[192:195], v9 offset:0
    v_add_u32 v9, s68, v9
    ds_read_b64_tr_b16 v[196:197], v16 offset:5184
    ds_read_b64_tr_b16 v[198:199], v16 offset:6464
    ds_read_b64_tr_b16 v[200:201], v16 offset:5248
    v_mfma_f32_32x32x16_bf16 v[80:95], v[168:171], v[176:179], v[80:95]
    ds_read_b64_tr_b16 v[202:203], v16 offset:6528
    ds_read_b64_tr_b16 v[204:205], v16 offset:5312
    ds_read_b64_tr_b16 v[206:207], v16 offset:6592
    ds_read_b64_tr_b16 v[208:209], v16 offset:5376
    v_mfma_f32_32x32x16_bf16 v[96:111], v[168:171], v[180:183], v[96:111]
    ds_read_b64_tr_b16 v[210:211], v16 offset:6656
    ds_read_b64_tr_b16 v[212:213], v16 offset:5440
    ds_read_b64_tr_b16 v[214:215], v16 offset:6720
    v_mfma_f32_32x32x16_bf16 v[112:127], v[168:171], v[184:187], v[112:127]
    v_mfma_f32_32x32x16_bf16 v[128:143], v[168:171], v[188:191], v[128:143]
    s_waitcnt lgkmcnt(0)
    v_mfma_f32_32x32x16_bf16 v[64:79], v[192:195], v[196:199], v[64:79]
    v_mfma_f32_32x32x16_bf16 v[80:95], v[192:195], v[200:203], v[80:95]
    v_mfma_f32_32x32x16_bf16 v[96:111], v[192:195], v[204:207], v[96:111]
    v_mfma_f32_32x32x16_bf16 v[112:127], v[192:195], v[208:211], v[112:127]
    v_mfma_f32_32x32x16_bf16 v[128:143], v[192:195], v[212:215], v[128:143]
    s_cmp_lg_u32 s78, 0
    s_cbranch_scc1 LGV_have
LGV_poll:
    buffer_load_dword v24, v5, s[20:23], 0 offen sc1
    s_waitcnt vmcnt(0)
    v_cmp_eq_u32 vcc, 0, v24
    s_nop 4
    s_cmp_eq_u64 vcc, 0
    s_cbranch_scc1 LGV_pollok
    s_sleep 1
    s_branch LGV_poll
LGV_pollok:
    s_mov_b32 s76, s29
    v_and_b32 v25, 31, v1
    v_add_u32 v26, s76, v25
    v_lshlrev_b32 v26, 2, v26
    s_mov_b32 s69, 19922944
    s_mov_b32 s70, 19931136
    buffer_load_dword v28, v26, s[16:19], s69 offen offset:0 sc1
    v_lshrrev_b32 v27, 5, v1
    v_lshlrev_b32 v27, 2, v27
    v_add_u32 v27, s76, v27
    v_lshlrev_b32 v27, 2, v27
    buffer_load_dwordx4 v[40:43], v27, s[16:19], s70 offen offset:0 sc1
    buffer_load_dwordx4 v[44:47], v27, s[16:19], s70 offen offset:32 sc1
    buffer_load_dwordx4 v[48:51], v27, s[16:19], s70 offen offset:64 sc1
    buffer_load_dwordx4 v[52:55], v27, s[16:19], s70 offen offset:96 sc1
    v_lshlrev_b32 v32, 2, v25
    s_mul_i32 s69, s28, 640
    s_add_u32 s69, s69, 19939328
    buffer_load_dword v228, v32, s[16:19], s69 offen offset:0 sc1
    buffer_load_dword v229, v32, s[16:19], s69 offen offset:128 sc1
    buffer_load_dword v230, v32, s[16:19], s69 offen offset:256 sc1
    buffer_load_dword v231, v32, s[16:19], s69 offen offset:384 sc1
    buffer_load_dword v232, v32, s[16:19], s69 offen offset:512 sc1
    s_add_u32 s69, s69, 19968
    buffer_load_dword v233, v32, s[16:19], s69 offen offset:0 sc1
    buffer_load_dword v234, v32, s[16:19], s69 offen offset:128 sc1
    buffer_load_dword v235, v32, s[16:19], s69 offen offset:256 sc1
    buffer_load_dword v236, v32, s[16:19], s69 offen offset:384 sc1
    buffer_load_dword v237, v32, s[16:19], s69 offen offset:512 sc1
    s_add_u32 s69, s69, 19968
    buffer_load_dword v238, v32, s[16:19], s69 offen offset:0 sc1
    buffer_load_dword v239, v32, s[16:19], s69 offen offset:128 sc1
    buffer_load_dword v240, v32, s[16:19], s69 offen offset:256 sc1
    buffer_load_dword v241, v32, s[16:19], s69 offen offset:384 sc1
    buffer_load_dword v242, v32, s[16:19], s69 offen offset:512 sc1
    s_add_u32 s69, s69, 19968
    buffer_load_dword v243, v32, s[16:19], s69 offen offset:0 sc1
    buffer_load_dword v244, v32, s[16:19], s69 offen offset:128 sc1
    buffer_load_dword v245, v32, s[16:19], s69 offen offset:256 sc1
    buffer_load_dword v246, v32, s[16:19], s69 offen offset:384 sc1
    buffer_load_dword v247, v32, s[16:19], s69 offen offset:512 sc1
LGV_have:
    s_waitcnt vmcnt(0)
    s_mov_b32 s64, -1
    s_mov_b32 s65, 0
    v_add_f32 v34, v228, v233
    v_add_f32 v238, v238, v243
    v_add_f32 v34, v34, v238
    v_add_f32 v35, v229, v234
    v_add_f32 v239, v239, v244
    v_add_f32 v35, v35, v239
    v_add_f32 v36, v230, v235
    v_add_f32 v240, v240, v245
    v_add_f32 v36, v36, v240
    v_add_f32 v37, v231, v236
    v_add_f32 v241, v241, v246
    v_add_f32 v37, v37, v241
    v_add_f32 v38, v232, v237
    v_add_f32 v242, v242, v247
    v_add_f32 v38, v38, v242
    v_xor_b32 v24, 0x80000000, v28
    v_lshrrev_b32 v25, 16, v24
    v_or_b32 v26, v25, v24
    v_cndmask_b32 v168, 0, v26, s[64:65]
    v_cndmask_b32 v169, 0, v25, s[64:65]
    v_mov_b32 v170, 0
    v_mov_b32 v171, 0
    v_and_b32 v24, 0xffff0000, v34
    v_sub_f32 v25, v34, v24
    v_and_b32 v26, 0xffff0000, v25
    v_sub_f32 v25, v25, v26
    v_lshrrev_b32 v24, 16, v24
    v_or_b32 v216, v24, v26
    v_lshrrev_b32 v217, 16, v25
    v_mov_b32 v218, 0
    v_mov_b32 v219, 0
    v_and_b32 v24, 0xffff0000, v35
    v_sub_f32 v25, v35, v24
    v_and_b32 v26, 0xffff0000, v25
    v_sub_f32 v25, v25, v26
    v_lshrrev_b32 v24, 16, v24
    v_or_b32 v220, v24, v26
    v_lshrrev_b32 v221, 16, v25
    v_mov_b32 v222, 0
    v_mov_b32 v223, 0
    v_mfma_f32_32x32x16_bf16 v[64:79], v[168:171], v[216:219], v[64:79]
    v_and_b32 v24, 0xffff0000, v36
    v_sub_f32 v25, v36, v24
    v_and_b32 v26, 0xffff0000, v25
    v_sub_f32 v25, v25, v26
    v_lshrrev_b32 v24, 16, v24
    v_or_b32 v224, v24, v26
    v_lshrrev_b32 v225, 16, v25
    v_mov_b32 v226, 0
    v_mov_b32 v227, 0
    v_mfma_f32_32x32x16_bf16 v[80:95], v[168:171], v[220:223], v[80:95]
    v_and_b32 v24, 0xffff0000, v37
    v_sub_f32 v25, v37, v24
    v_and_b32 v26, 0xffff0000, v25
    v_sub_f32 v25, v25, v26
    v_lshrrev_b32 v24, 16, v24
    v_or_b32 v176, v24, v26
    v_lshrrev_b32 v177, 16, v25
    v_mov_b32 v178, 0
    v_mov_b32 v179, 0
    v_mfma_f32_32x32x16_bf16 v[96:111], v[168:171], v[224:227], v[96:111]
    v_and_b32 v24, 0xffff0000, v38
    v_sub_f32 v25, v38, v24
    v_and_b32 v26, 0xffff0000, v25
    v_sub_f32 v25, v25, v26
    v_lshrrev_b32 v24, 16, v24
    v_or_b32 v180, v24, v26
    v_lshrrev_b32 v181, 16, v25
    v_mov_b32 v182, 0
    v_mov_b32 v183, 0
    s_nop 1
    v_mfma_f32_32x32x16_bf16 v[112:127], v[168:171], v[176:179], v[112:127]
    v_mfma_f32_32x32x16_bf16 v[128:143], v[168:171], v[180:183], v[128:143]
    s_lshr_b32 s69, s76, 5
    s_sub_u32 s72, s28, 8
    s_mul_i32 s72, s72, 655360
    s_mul_i32 s71, s69, 1280
    s_add_u32 s71, s71, s72
    s_add_u32 s71, s71, 5242880
    s_mov_b32 s72, 81920
    v_and_b32 v2, 31, v1
    v_lshrrev_b32 v3, 5, v1
    v_mul_u32_u24 v3, 320, v3
    v_add_u32 v24, 0, v2
    v_mul_u32_u24 v25, 52429, v24
    v_lshrrev_b32 v25, 20, v25
    v_mul_u32_u24 v26, 20, v25
    v_sub_u32 v26, v24, v26
    v_mul_lo_u32 v25, v25, s72
    v_lshl_add_u32 v25, v26, 4, v25
    v_add_u32 v28, v25, v3
    v_add_u32 v24, 32, v2
    v_mul_u32_u24 v25, 52429, v24
    v_lshrrev_b32 v25, 20, v25
    v_mul_u32_u24 v26, 20, v25
    v_sub_u32 v26, v24, v26
    v_mul_lo_u32 v25, v25, s72
    v_lshl_add_u32 v25, v26, 4, v25
    v_add_u32 v29, v25, v3
    v_add_u32 v24, 64, v2
    v_mul_u32_u24 v25, 52429, v24
    v_lshrrev_b32 v25, 20, v25
    v_mul_u32_u24 v26, 20, v25
    v_sub_u32 v26, v24, v26
    v_mul_lo_u32 v25, v25, s72
    v_lshl_add_u32 v25, v26, 4, v25
    v_add_u32 v30, v25, v3
    v_add_u32 v24, 96, v2
    v_mul_u32_u24 v25, 52429, v24
    v_lshrrev_b32 v25, 20, v25
    v_mul_u32_u24 v26, 20, v25
    v_sub_u32 v26, v24, v26
    v_mul_lo_u32 v25, v25, s72
    v_lshl_add_u32 v25, v26, 4, v25
    v_add_u32 v31, v25, v3
    v_add_u32 v24, 128, v2
    v_mul_u32_u24 v25, 52429, v24
    v_lshrrev_b32 v25, 20, v25
    v_mul_u32_u24 v26, 20, v25
    v_sub_u32 v26, v24, v26
    v_mul_lo_u32 v25, v25, s72
    v_lshl_add_u32 v25, v26, 4, v25
    v_add_u32 v32, v25, v3
    v_mul_f32 v64, v64, v40
    v_mul_f32 v65, v65, v41
    v_mul_f32 v66, v66, v42
    v_mul_f32 v67, v67, v43
    v_mul_f32 v68, v68, v44
    v_mul_f32 v69, v69, v45
    v_mul_f32 v70, v70, v46
    v_mul_f32 v71, v71, v47
    v_mul_f32 v72, v72, v48
    v_mul_f32 v73, v73, v49
    v_mul_f32 v74, v74, v50
    v_mul_f32 v75, v75, v51
    v_mul_f32 v76, v76, v52
    v_mul_f32 v77, v77, v53
    v_mul_f32 v78, v78, v54
    v_mul_f32 v79, v79, v55
    v_cvt_pk_bf16_f32 v168, v64, v65
    v_cvt_pk_bf16_f32 v169, v66, v67
    v_cvt_pk_bf16_f32 v170, v68, v69
    v_cvt_pk_bf16_f32 v171, v70, v71
    v_cvt_pk_bf16_f32 v172, v72, v73
    v_cvt_pk_bf16_f32 v173, v74, v75
    v_cvt_pk_bf16_f32 v174, v76, v77
    v_cvt_pk_bf16_f32 v175, v78, v79
    buffer_store_dwordx4 v[168:171], v28, s[16:19], s71 offen sc1
    buffer_store_dwordx4 v[172:175], v28, s[16:19], s71 offen offset:640 sc1
    v_mul_f32 v80, v80, v40
    v_mul_f32 v81, v81, v41
    v_mul_f32 v82, v82, v42
    v_mul_f32 v83, v83, v43
    v_mul_f32 v84, v84, v44
    v_mul_f32 v85, v85, v45
    v_mul_f32 v86, v86, v46
    v_mul_f32 v87, v87, v47
    v_mul_f32 v88, v88, v48
    v_mul_f32 v89, v89, v49
    v_mul_f32 v90, v90, v50
    v_mul_f32 v91, v91, v51
    v_mul_f32 v92, v92, v52
    v_mul_f32 v93, v93, v53
    v_mul_f32 v94, v94, v54
    v_mul_f32 v95, v95, v55
    v_cvt_pk_bf16_f32 v176, v80, v81
    v_cvt_pk_bf16_f32 v177, v82, v83
    v_cvt_pk_bf16_f32 v178, v84, v85
    v_cvt_pk_bf16_f32 v179, v86, v87
    v_cvt_pk_bf16_f32 v180, v88, v89
    v_cvt_pk_bf16_f32 v181, v90, v91
    v_cvt_pk_bf16_f32 v182, v92, v93
    v_cvt_pk_bf16_f32 v183, v94, v95
    buffer_store_dwordx4 v[176:179], v29, s[16:19], s71 offen sc1
    buffer_store_dwordx4 v[180:183], v29, s[16:19], s71 offen offset:640 sc1
    v_mul_f32 v96, v96, v40
    v_mul_f32 v97, v97, v41
    v_mul_f32 v98, v98, v42
    v_mul_f32 v99, v99, v43
    v_mul_f32 v100, v100, v44
    v_mul_f32 v101, v101, v45
    v_mul_f32 v102, v102, v46
    v_mul_f32 v103, v103, v47
    v_mul_f32 v104, v104, v48
    v_mul_f32 v105, v105, v49
    v_mul_f32 v106, v106, v50
    v_mul_f32 v107, v107, v51
    v_mul_f32 v108, v108, v52
    v_mul_f32 v109, v109, v53
    v_mul_f32 v110, v110, v54
    v_mul_f32 v111, v111, v55
    v_cvt_pk_bf16_f32 v184, v96, v97
    v_cvt_pk_bf16_f32 v185, v98, v99
    v_cvt_pk_bf16_f32 v186, v100, v101
    v_cvt_pk_bf16_f32 v187, v102, v103
    v_cvt_pk_bf16_f32 v188, v104, v105
    v_cvt_pk_bf16_f32 v189, v106, v107
    v_cvt_pk_bf16_f32 v190, v108, v109
    v_cvt_pk_bf16_f32 v191, v110, v111
    buffer_store_dwordx4 v[184:187], v30, s[16:19], s71 offen sc1
    buffer_store_dwordx4 v[188:191], v30, s[16:19], s71 offen offset:640 sc1
    v_mul_f32 v112, v112, v40
    v_mul_f32 v113, v113, v41
    v_mul_f32 v114, v114, v42
    v_mul_f32 v115, v115, v43
    v_mul_f32 v116, v116, v44
    v_mul_f32 v117, v117, v45
    v_mul_f32 v118, v118, v46
    v_mul_f32 v119, v119, v47
    v_mul_f32 v120, v120, v48
    v_mul_f32 v121, v121, v49
    v_mul_f32 v122, v122, v50
    v_mul_f32 v123, v123, v51
    v_mul_f32 v124, v124, v52
    v_mul_f32 v125, v125, v53
    v_mul_f32 v126, v126, v54
    v_mul_f32 v127, v127, v55
    v_cvt_pk_bf16_f32 v192, v112, v113
    v_cvt_pk_bf16_f32 v193, v114, v115
    v_cvt_pk_bf16_f32 v194, v116, v117
    v_cvt_pk_bf16_f32 v195, v118, v119
    v_cvt_pk_bf16_f32 v196, v120, v121
    v_cvt_pk_bf16_f32 v197, v122, v123
    v_cvt_pk_bf16_f32 v198, v124, v125
    v_cvt_pk_bf16_f32 v199, v126, v127
    buffer_store_dwordx4 v[192:195], v31, s[16:19], s71 offen sc1
    buffer_store_dwordx4 v[196:199], v31, s[16:19], s71 offen offset:640 sc1
    v_mul_f32 v128, v128, v40
    v_mul_f32 v129, v129, v41
    v_mul_f32 v130, v130, v42
    v_mul_f32 v131, v131, v43
    v_mul_f32 v132, v132, v44
    v_mul_f32 v133, v133, v45
    v_mul_f32 v134, v134, v46
    v_mul_f32 v135, v135, v47
    v_mul_f32 v136, v136, v48
    v_mul_f32 v137, v137, v49
    v_mul_f32 v138, v138, v50
    v_mul_f32 v139, v139, v51
    v_mul_f32 v140, v140, v52
    v_mul_f32 v141, v141, v53
    v_mul_f32 v142, v142, v54
    v_mul_f32 v143, v143, v55
    v_cvt_pk_bf16_f32 v200, v128, v129
    v_cvt_pk_bf16_f32 v201, v130, v131
    v_cvt_pk_bf16_f32 v202, v132, v133
    v_cvt_pk_bf16_f32 v203, v134, v135
    v_cvt_pk_bf16_f32 v204, v136, v137
    v_cvt_pk_bf16_f32 v205, v138, v139
    v_cvt_pk_bf16_f32 v206, v140, v141
    v_cvt_pk_bf16_f32 v207, v142, v143
    buffer_store_dwordx4 v[200:203], v32, s[16:19], s71 offen sc1
    buffer_store_dwordx4 v[204:207], v32, s[16:19], s71 offen offset:640 sc1
    s_endpgm
LGGU:
    s_mul_i32 s58, s28, 192
    s_and_b32 s57, s24, 3
    s_mul_i32 s59, s57, 1568
    s_mul_i32 s60, s81, 6304
    s_add_u32 s59, s59, s60
    s_mul_i32 s60, s57, 96
    s_lshl_b32 s56, s80, 13
    s_add_u32 s59, s59, 98304
    s_mov_b32 s62, 3072
    v_add_u32 v6, s56, v6
    v_add_u32 v7, s56, v7
    v_add_u32 v8, s56, v8
    v_add_u32 v9, s56, v9
    v_add_u32 v24, s60, v1
    v_add_u32 v24, 0, v24
    v_mul_u32_u24 v25, 43691, v24
    v_lshrrev_b32 v25, 19, v25
    v_mul_u32_u24 v26, 12, v25
    v_sub_u32 v26, v24, v26
    v_mul_lo_u32 v25, v25, s62
    v_lshl_add_u32 v25, v26, 4, v25
    v_add_u32 v14, s58, v25
    v_add_u32 v24, s60, v1
    v_add_u32 v24, 64, v24
    v_mul_u32_u24 v25, 43691, v24
    v_lshrrev_b32 v25, 19, v25
    v_mul_u32_u24 v26, 12, v25
    v_sub_u32 v26, v24, v26
    v_mul_lo_u32 v25, v25, s62
    v_lshl_add_u32 v25, v26, 4, v25
    v_add_u32 v15, s58, v25
    v_subrev_u32 v15, 1024, v15
    s_mov_b32 s64, 0xffffffff
    s_mov_b32 s65, 0
    s_mov_b32 s30, 0
    s_mov_b32 s31, 0
    s_mov_b32 s32, 0
    s_mov_b32 s33, 0
    s_mov_b32 s66, 0
    s_mov_b32 s67, 0
    s_waitcnt lgkmcnt(0)
    s_mov_b32 s8, s36
    s_mov_b32 s9, s37
    s_mov_b32 s10, 2621440
    s_mov_b32 s11, 0x00020000
    s_cmp_ge_u32 s24, 4
    s_cselect_b32 s12, s46, s44
    s_cselect_b32 s13, s47, s45
    s_mov_b32 s14, 1966080
    s_mov_b32 s15, 0x00020000
    s_add_u32 m0, s59, s33
    s_nop 0
    buffer_load_dwordx4 v14, s[12:15], s31 offen lds
    s_add_u32 m0, s59, s33
    s_mov_b64 exec, s[64:65]
    buffer_load_dwordx4 v15, s[12:15], s31 offen offset:1024 lds
    s_mov_b64 exec, -1
    s_add_u32 s33, s33, 12576
    s_cmp_eq_u32 s33, 62880
    s_cselect_b32 s33, 0, s33
    s_add_u32 s31, s31, 98304
    s_add_u32 m0, s63, s32
    s_nop 0
    buffer_load_dwordx4 v10, s[8:11], s30 offen offset:0 lds
    s_add_u32 m0, s63, s32
    s_nop 0
    buffer_load_dwordx4 v11, s[8:11], s30 offen offset:1024 lds
    s_add_u32 m0, s63, s32
    s_nop 0
    buffer_load_dwordx4 v12, s[8:11], s30 offen offset:2048 lds
    s_add_u32 m0, s63, s32
    s_nop 0
    buffer_load_dwordx4 v13, s[8:11], s30 offen offset:3072 lds
    s_add_u32 s32, s32, 32768
    s_cmp_eq_u32 s32, 98304
    s_cselect_b32 s32, 0, s32
    s_add_u32 s30, s30, 128
    s_add_u32 m0, s59, s33
    s_nop 0
    buffer_load_dwordx4 v14, s[12:15], s31 offen lds
    s_add_u32 m0, s59, s33
    s_mov_b64 exec, s[64:65]
    buffer_load_dwordx4 v15, s[12:15], s31 offen offset:1024 lds
    s_mov_b64 exec, -1
    s_add_u32 s33, s33, 12576
    s_cmp_eq_u32 s33, 62880
    s_cselect_b32 s33, 0, s33
    s_add_u32 s31, s31, 98304
    s_add_u32 m0, s59, s33
    s_nop 0
    buffer_load_dwordx4 v14, s[12:15], s31 offen lds
    s_add_u32 m0, s59, s33
    s_mov_b64 exec, s[64:65]
    buffer_load_dwordx4 v15, s[12:15], s31 offen offset:1024 lds
    s_mov_b64 exec, -1
    s_add_u32 s33, s33, 12576
    s_cmp_eq_u32 s33, 62880
    s_cselect_b32 s33, 0, s33
    s_add_u32 s31, s31, 98304
    s_add_u32 m0, s63, s32
    s_nop 0
    buffer_load_dwordx4 v10, s[8:11], s30 offen offset:0 lds
    s_add_u32 m0, s63, s32
    s_nop 0
    buffer_load_dwordx4 v11, s[8:11], s30 offen offset:1024 lds
    s_add_u32 m0, s63, s32
    s_nop 0
    buffer_load_dwordx4 v12, s[8:11], s30 offen offset:2048 lds
    s_add_u32 m0, s63, s32
    s_nop 0
    buffer_load_dwordx4 v13, s[8:11], s30 offen offset:3072 lds
    s_add_u32 s32, s32, 32768
    s_cmp_eq_u32 s32, 98304
    s_cselect_b32 s32, 0, s32
    s_add_u32 s30, s30, 128
    s_add_u32 m0, s59, s33
    s_nop 0
    buffer_load_dwordx4 v14, s[12:15], s31 offen lds
    s_add_u32 m0, s59, s33
    s_mov_b64 exec, s[64:65]
    buffer_load_dwordx4 v15, s[12:15], s31 offen offset:1024 lds
    s_mov_b64 exec, -1
    s_add_u32 s33, s33, 12576
    s_cmp_eq_u32 s33, 62880
    s_cselect_b32 s33, 0, s33
    s_add_u32 s31, s31, 98304
    s_mov_b32 s16, s54
    s_mov_b32 s17, s55
    s_mov_b32 s18, 268435456
    s_mov_b32 s19, 0x00020000
    s_mov_b32 s20, s52
    s_mov_b32 s21, s53
    s_mov_b32 s22, 256
    s_mov_b32 s23, 0x00020000
    v_bfe_u32 v26, v1, 2, 2
    v_mul_u32_u24 v26, 192, v26
    v_and_b32 v27, 3, v1
    v_lshl_add_u32 v26, v27, 3, v26
    v_lshrrev_b32 v24, 5, v1
    v_mul_u32_u24 v24, 1568, v24
    v_bfe_u32 v27, v1, 4, 1
    v_mul_u32_u24 v27, 6304, v27
    v_add3_u32 v16, v24, v26, v27
    s_mul_i32 s61, s81, 96
    s_add_u32 s61, s61, 98304
    v_add_u32 v16, s61, v16
    v_mov_b32 v64, 0
    v_mov_b32 v65, 0
    v_mov_b32 v66, 0
    v_mov_b32 v67, 0
    v_mov_b32 v68, 0
    v_mov_b32 v69, 0
    v_mov_b32 v70, 0
    v_mov_b32 v71, 0
    v_mov_b32 v72, 0
    v_mov_b32 v73, 0
    v_mov_b32 v74, 0
    v_mov_b32 v75, 0
    v_mov_b32 v76, 0
    v_mov_b32 v77, 0
    v_mov_b32 v78, 0
    v_mov_b32 v79, 0
    v_mov_b32 v80, 0
    v_mov_b32 v81, 0
    v_mov_b32 v82, 0
    v_mov_b32 v83, 0
    v_mov_b32 v84, 0
    v_mov_b32 v85, 0
    v_mov_b32 v86, 0
    v_mov_b32 v87, 0
    v_mov_b32 v88, 0
    v_mov_b32 v89, 0
    v_mov_b32 v90, 0
    v_mov_b32 v91, 0
    v_mov_b32 v92, 0
    v_mov_b32 v93, 0
    v_mov_b32 v94, 0
    v_mov_b32 v95, 0
    v_mov_b32 v96, 0
    v_mov_b32 v97, 0
    v_mov_b32 v98, 0
    v_mov_b32 v99, 0
    v_mov_b32 v100, 0
    v_mov_b32 v101, 0
    v_mov_b32 v102, 0
    v_mov_b32 v103, 0
    v_mov_b32 v104, 0
    v_mov_b32 v105, 0
    v_mov_b32 v106, 0
    v_mov_b32 v107, 0
    v_mov_b32 v108, 0
    v_mov_b32 v109, 0
    v_mov_b32 v110, 0
    v_mov_b32 v111, 0
    v_mov_b32 v112, 0
    v_mov_b32 v113, 0
    v_mov_b32 v114, 0
    v_mov_b32 v115, 0
    v_mov_b32 v116, 0
    v_mov_b32 v117, 0
    v_mov_b32 v118, 0
    v_mov_b32 v119, 0
    v_mov_b32 v120, 0
    v_mov_b32 v121, 0
    v_mov_b32 v122, 0
    v_mov_b32 v123, 0
    v_mov_b32 v124, 0
    v_mov_b32 v125, 0
    v_mov_b32 v126, 0
    v_mov_b32 v127, 0
    v_mov_b32 v128, 0
    v_mov_b32 v129, 0
    v_mov_b32 v130, 0
    v_mov_b32 v131, 0
    v_mov_b32 v132, 0
    v_mov_b32 v133, 0
    v_mov_b32 v134, 0
    v_mov_b32 v135, 0
    v_mov_b32 v136, 0
    v_mov_b32 v137, 0
    v_mov_b32 v138, 0
    v_mov_b32 v139, 0
    v_mov_b32 v140, 0
    v_mov_b32 v141, 0
    v_mov_b32 v142, 0
    v_mov_b32 v143, 0
    v_mov_b32 v144, 0
    v_mov_b32 v145, 0
    v_mov_b32 v146, 0
    v_mov_b32 v147, 0
    v_mov_b32 v148, 0
    v_mov_b32 v149, 0
    v_mov_b32 v150, 0
    v_mov_b32 v151, 0
    v_mov_b32 v152, 0
    v_mov_b32 v153, 0
    v_mov_b32 v154, 0
    v_mov_b32 v155, 0
    v_mov_b32 v156, 0
    v_mov_b32 v157, 0
    v_mov_b32 v158, 0
    v_mov_b32 v159, 0
    s_waitcnt vmcnt(8) lgkmcnt(0)
    s_barrier
    ds_read_b128 v[168:171], v6 offset:0
    ds_read_b128 v[172:175], v6 offset:4096
    ds_read_b64_tr_b16 v[176:177], v16 offset:0
    ds_read_b64_tr_b16 v[178:179], v16 offset:768
    ds_read_b64_tr_b16 v[180:181], v16 offset:32
    ds_read_b64_tr_b16 v[182:183], v16 offset:800
    ds_read_b64_tr_b16 v[184:185], v16 offset:64
    ds_read_b64_tr_b16 v[186:187], v16 offset:832
    s_add_u32 s69, s66, 32768
    s_cmp_eq_u32 s69, 98304
    s_cselect_b32 s69, 0, s69
    s_sub_u32 s68, s69, s66
    s_mov_b32 s66, s69
    v_add_u32 v6, s68, v6
    s_mov_b32 s34, 8
    s_branch LGGU_in
.p2align 6
LGGU_loop:
    s_waitcnt vmcnt(8)
    s_barrier
LGGU_in:
    s_waitcnt lgkmcnt(0)
    v_mfma_f32_32x32x16_bf16 v[64:79], v[176:179], v[168:171], v[64:79]
    ds_read_b128 v[192:195], v7 offset:0
    ds_read_b128 v[196:199], v7 offset:4096
    v_add_u32 v7, s68, v7
    s_add_u32 m0, s59, s33
    s_nop 0
    buffer_load_dwordx4 v14, s[12:15], s31 offen lds
    v_mfma_f32_32x32x16_bf16 v[112:127], v[176:179], v[172:175], v[112:127]
    ds_read_b64_tr_b16 v[200:201], v16 offset:3136
    ds_read_b64_tr_b16 v[202:203], v16 offset:3904
    v_mfma_f32_32x32x16_bf16 v[80:95], v[180:183], v[168:171], v[80:95]
    ds_read_b64_tr_b16 v[204:205], v16 offset:3168
    ds_read_b64_tr_b16 v[206:207], v16 offset:3936
    s_add_u32 m0, s59, s33
    s_mov_b64 exec, s[64:65]
    buffer_load_dwordx4 v15, s[12:15], s31 offen offset:1024 lds
    s_mov_b64 exec, -1
    s_add_u32 s33, s33, 12576
    s_cmp_eq_u32 s33, 62880
    s_cselect_b32 s33, 0, s33
    s_add_u32 s31, s31, 98304
    v_mfma_f32_32x32x16_bf16 v[128:143], v[180:183], v[172:175], v[128:143]
    ds_read_b64_tr_b16 v[208:209], v16 offset:3200
    ds_read_b64_tr_b16 v[210:211], v16 offset:3968
    v_mfma_f32_32x32x16_bf16 v[96:111], v[184:187], v[168:171], v[96:111]
    s_add_u32 m0, s63, s32
    s_nop 0
    buffer_load_dwordx4 v10, s[8:11], s30 offen offset:0 lds
    v_mfma_f32_32x32x16_bf16 v[144:159], v[184:187], v[172:175], v[144:159]
    s_waitcnt lgkmcnt(0)
    s_add_u32 s69, s67, 12576
    s_cmp_eq_u32 s69, 62880
    s_cselect_b32 s69, 0, s69
    s_sub_u32 s70, s69, s67
    s_mov_b32 s67, s69
    v_add_u32 v16, s70, v16
    v_mfma_f32_32x32x16_bf16 v[64:79], v[200:203], v[192:195], v[64:79]
    ds_read_b128 v[168:171], v8 offset:0
    ds_read_b128 v[172:175], v8 offset:4096
    v_add_u32 v8, s68, v8
    s_add_u32 m0, s63, s32
    s_nop 0
    buffer_load_dwordx4 v11, s[8:11], s30 offen offset:1024 lds
    v_mfma_f32_32x32x16_bf16 v[112:127], v[200:203], v[196:199], v[112:127]
    ds_read_b64_tr_b16 v[176:177], v16 offset:0
    ds_read_b64_tr_b16 v[178:179], v16 offset:768
    v_mfma_f32_32x32x16_bf16 v[80:95], v[204:207], v[192:195], v[80:95]
    ds_read_b64_tr_b16 v[180:181], v16 offset:32
    ds_read_b64_tr_b16 v[182:183], v16 offset:800
    s_add_u32 m0, s63, s32
    s_nop 0
    buffer_load_dwordx4 v12, s[8:11], s30 offen offset:2048 lds
    v_mfma_f32_32x32x16_bf16 v[128:143], v[204:207], v[196:199], v[128:143]
    ds_read_b64_tr_b16 v[184:185], v16 offset:64
    ds_read_b64_tr_b16 v[186:187], v16 offset:832
    v_mfma_f32_32x32x16_bf16 v[96:111], v[208:211], v[192:195], v[96:111]
    s_add_u32 m0, s63, s32
    s_nop 0
    buffer_load_dwordx4 v13, s[8:11], s30 offen offset:3072 lds
    s_add_u32 s32, s32, 32768
    s_cmp_eq_u32 s32, 98304
    s_cselect_b32 s32, 0, s32
    s_add_u32 s30, s30, 128
    v_mfma_f32_32x32x16_bf16 v[144:159], v[208:211], v[196:199], v[144:159]
    s_waitcnt vmcnt(8)
    s_barrier
    s_waitcnt lgkmcnt(0)
    v_mfma_f32_32x32x16_bf16 v[64:79], v[176:179], v[168:171], v[64:79]
    ds_read_b128 v[192:195], v9 offset:0
    ds_read_b128 v[196:199], v9 offset:4096
    v_add_u32 v9, s68, v9
    v_mfma_f32_32x32x16_bf16 v[112:127], v[176:179], v[172:175], v[112:127]
    ds_read_b64_tr_b16 v[200:201], v16 offset:3136
    ds_read_b64_tr_b16 v[202:203], v16 offset:3904
    v_mfma_f32_32x32x16_bf16 v[80:95], v[180:183], v[168:171], v[80:95]
    ds_read_b64_tr_b16 v[204:205], v16 offset:3168
    ds_read_b64_tr_b16 v[206:207], v16 offset:3936
    v_mfma_f32_32x32x16_bf16 v[128:143], v[180:183], v[172:175], v[128:143]
    ds_read_b64_tr_b16 v[208:209], v16 offset:3200
    ds_read_b64_tr_b16 v[210:211], v16 offset:3968
    v_mfma_f32_32x32x16_bf16 v[96:111], v[184:187], v[168:171], v[96:111]
    s_add_u32 m0, s59, s33
    s_nop 0
    buffer_load_dwordx4 v14, s[12:15], s31 offen lds
    v_mfma_f32_32x32x16_bf16 v[144:159], v[184:187], v[172:175], v[144:159]
    s_waitcnt lgkmcnt(0)
    s_add_u32 s69, s67, 12576
    s_cmp_eq_u32 s69, 62880
    s_cselect_b32 s69, 0, s69
    s_sub_u32 s70, s69, s67
    s_mov_b32 s67, s69
    v_add_u32 v16, s70, v16
    v_mfma_f32_32x32x16_bf16 v[64:79], v[200:203], v[192:195], v[64:79]
    ds_read_b128 v[168:171], v6 offset:0
    ds_read_b128 v[172:175], v6 offset:4096
    s_add_u32 s69, s66, 32768
    s_cmp_eq_u32 s69, 98304
    s_cselect_b32 s69, 0, s69
    s_sub_u32 s68, s69, s66
    s_mov_b32 s66, s69
    v_add_u32 v6, s68, v6
    v_mfma_f32_32x32x16_bf16 v[112:127], v[200:203], v[196:199], v[112:127]
    ds_read_b64_tr_b16 v[176:177], v16 offset:0
    ds_read_b64_tr_b16 v[178:179], v16 offset:768
    v_mfma_f32_32x32x16_bf16 v[80:95], v[204:207], v[192:195], v[80:95]
    ds_read_b64_tr_b16 v[180:181], v16 offset:32
    ds_read_b64_tr_b16 v[182:183], v16 offset:800
    v_mfma_f32_32x32x16_bf16 v[128:143], v[204:207], v[196:199], v[128:143]
    ds_read_b64_tr_b16 v[184:185], v16 offset:64
    ds_read_b64_tr_b16 v[186:187], v16 offset:832
    v_mfma_f32_32x32x16_bf16 v[96:111], v[208:211], v[192:195], v[96:111]
    s_add_u32 m0, s59, s33
    s_mov_b64 exec, s[64:65]
    buffer_load_dwordx4 v15, s[12:15], s31 offen offset:1024 lds
    s_mov_b64 exec, -1
    s_add_u32 s33, s33, 12576
    s_cmp_eq_u32 s33, 62880
    s_cselect_b32 s33, 0, s33
    s_add_u32 s31, s31, 98304
    v_mfma_f32_32x32x16_bf16 v[144:159], v[208:211], v[196:199], v[144:159]
    s_sub_u32 s34, s34, 1
    s_cmp_lg_u32 s34, 0
    s_cbranch_scc1 LGGU_loop
    s_waitcnt vmcnt(8)
    s_barrier
    s_waitcnt lgkmcnt(0)
    v_mfma_f32_32x32x16_bf16 v[64:79], v[176:179], v[168:171], v[64:79]
    ds_read_b128 v[192:195], v7 offset:0
    ds_read_b128 v[196:199], v7 offset:4096
    v_add_u32 v7, s68, v7
    v_mfma_f32_32x32x16_bf16 v[112:127], v[176:179], v[172:175], v[112:127]
    ds_read_b64_tr_b16 v[200:201], v16 offset:3136
    ds_read_b64_tr_b16 v[202:203], v16 offset:3904
    v_mfma_f32_32x32x16_bf16 v[80:95], v[180:183], v[168:171], v[80:95]
    ds_read_b64_tr_b16 v[204:205], v16 offset:3168
    ds_read_b64_tr_b16 v[206:207], v16 offset:3936
    v_mfma_f32_32x32x16_bf16 v[128:143], v[180:183], v[172:175], v[128:143]
    ds_read_b64_tr_b16 v[208:209], v16 offset:3200
    ds_read_b64_tr_b16 v[210:211], v16 offset:3968
    v_mfma_f32_32x32x16_bf16 v[96:111], v[184:187], v[168:171], v[96:111]
    v_mfma_f32_32x32x16_bf16 v[144:159], v[184:187], v[172:175], v[144:159]
    s_waitcnt lgkmcnt(0)
    s_add_u32 s69, s67, 12576
    s_cmp_eq_u32 s69, 62880
    s_cselect_b32 s69, 0, s69
    s_sub_u32 s70, s69, s67
    s_mov_b32 s67, s69
    v_add_u32 v16, s70, v16
    v_mfma_f32_32x32x16_bf16 v[64:79], v[200:203], v[192:195], v[64:79]
    ds_read_b128 v[168:171], v8 offset:0
    ds_read_b128 v[172:175], v8 offset:4096
    v_add_u32 v8, s68, v8
    v_mfma_f32_32x32x16_bf16 v[112:127], v[200:203], v[196:199], v[112:127]
    ds_read_b64_tr_b16 v[176:177], v16 offset:0
    ds_read_b64_tr_b16 v[178:179], v16 offset:768
    v_mfma_f32_32x32x16_bf16 v[80:95], v[204:207], v[192:195], v[80:95]
    ds_read_b64_tr_b16 v[180:181], v16 offset:32
    ds_read_b64_tr_b16 v[182:183], v16 offset:800
    v_mfma_f32_32x32x16_bf16 v[128:143], v[204:207], v[196:199], v[128:143]
    ds_read_b64_tr_b16 v[184:185], v16 offset:64
    ds_read_b64_tr_b16 v[186:187], v16 offset:832
    v_mfma_f32_32x32x16_bf16 v[96:111], v[208:211], v[192:195], v[96:111]
    v_mfma_f32_32x32x16_bf16 v[144:159], v[208:211], v[196:199], v[144:159]
    s_waitcnt vmcnt(2)
    s_barrier
    s_waitcnt lgkmcnt(0)
    v_mfma_f32_32x32x16_bf16 v[64:79], v[176:179], v[168:171], v[64:79]
    ds_read_b128 v[192:195], v9 offset:0
    ds_read_b128 v[196:199], v9 offset:4096
    v_add_u32 v9, s68, v9
    v_mfma_f32_32x32x16_bf16 v[112:127], v[176:179], v[172:175], v[112:127]
    ds_read_b64_tr_b16 v[200:201], v16 offset:3136
    ds_read_b64_tr_b16 v[202:203], v16 offset:3904
    v_mfma_f32_32x32x16_bf16 v[80:95], v[180:183], v[168:171], v[80:95]
    ds_read_b64_tr_b16 v[204:205], v16 offset:3168
    ds_read_b64_tr_b16 v[206:207], v16 offset:3936
    v_mfma_f32_32x32x16_bf16 v[128:143], v[180:183], v[172:175], v[128:143]
    ds_read_b64_tr_b16 v[208:209], v16 offset:3200
    ds_read_b64_tr_b16 v[210:211], v16 offset:3968
    v_mfma_f32_32x32x16_bf16 v[96:111], v[184:187], v[168:171], v[96:111]
    v_mfma_f32_32x32x16_bf16 v[144:159], v[184:187], v[172:175], v[144:159]
    s_waitcnt lgkmcnt(0)
    s_add_u32 s69, s67, 12576
    s_cmp_eq_u32 s69, 62880
    s_cselect_b32 s69, 0, s69
    s_sub_u32 s70, s69, s67
    s_mov_b32 s67, s69
    v_add_u32 v16, s70, v16
    v_mfma_f32_32x32x16_bf16 v[64:79], v[200:203], v[192:195], v[64:79]
    ds_read_b128 v[168:171], v6 offset:0
    ds_read_b128 v[172:175], v6 offset:4096
    s_add_u32 s69, s66, 32768
    s_cmp_eq_u32 s69, 98304
    s_cselect_b32 s69, 0, s69
    s_sub_u32 s68, s69, s66
    s_mov_b32 s66, s69
    v_add_u32 v6, s68, v6
    v_mfma_f32_32x32x16_bf16 v[112:127], v[200:203], v[196:199], v[112:127]
    ds_read_b64_tr_b16 v[176:177], v16 offset:0
    ds_read_b64_tr_b16 v[178:179], v16 offset:768
    v_mfma_f32_32x32x16_bf16 v[80:95], v[204:207], v[192:195], v[80:95]
    ds_read_b64_tr_b16 v[180:181], v16 offset:32
    ds_read_b64_tr_b16 v[182:183], v16 offset:800
    v_mfma_f32_32x32x16_bf16 v[128:143], v[204:207], v[196:199], v[128:143]
    ds_read_b64_tr_b16 v[184:185], v16 offset:64
    ds_read_b64_tr_b16 v[186:187], v16 offset:832
    v_mfma_f32_32x32x16_bf16 v[96:111], v[208:211], v[192:195], v[96:111]
    v_mfma_f32_32x32x16_bf16 v[144:159], v[208:211], v[196:199], v[144:159]
    s_waitcnt vmcnt(0)
    s_barrier
    buffer_load_dword v24, v5, s[20:23], 0 offen sc1
    s_waitcnt lgkmcnt(0)
    v_mfma_f32_32x32x16_bf16 v[64:79], v[176:179], v[168:171], v[64:79]
    ds_read_b128 v[192:195], v7 offset:0
    ds_read_b128 v[196:199], v7 offset:4096
    v_add_u32 v7, s68, v7
    v_mfma_f32_32x32x16_bf16 v[112:127], v[176:179], v[172:175], v[112:127]
    ds_read_b64_tr_b16 v[200:201], v16 offset:3136
    ds_read_b64_tr_b16 v[202:203], v16 offset:3904
    v_mfma_f32_32x32x16_bf16 v[80:95], v[180:183], v[168:171], v[80:95]
    ds_read_b64_tr_b16 v[204:205], v16 offset:3168
    ds_read_b64_tr_b16 v[206:207], v16 offset:3936
    v_mfma_f32_32x32x16_bf16 v[128:143], v[180:183], v[172:175], v[128:143]
    ds_read_b64_tr_b16 v[208:209], v16 offset:3200
    ds_read_b64_tr_b16 v[210:211], v16 offset:3968
    v_mfma_f32_32x32x16_bf16 v[96:111], v[184:187], v[168:171], v[96:111]
    v_mfma_f32_32x32x16_bf16 v[144:159], v[184:187], v[172:175], v[144:159]
    s_waitcnt vmcnt(0)
    v_cmp_eq_u32 vcc, 0, v24
    s_mov_b32 s78, 0
    s_nop 3
    s_cmp_eq_u64 vcc, 0
    s_cbranch_scc0 LGGU_notyet
    s_mov_b32 s78, 1
    s_lshl_b32 s76, s27, 8
    s_lshl_b32 s77, s80, 6
    s_add_u32 s76, s76, s77
    v_and_b32 v25, 31, v1
    v_add_u32 v26, s76, v25
    v_lshlrev_b32 v26, 2, v26
    s_mov_b32 s69, 19922944
    s_mov_b32 s70, 19931136
    buffer_load_dword v28, v26, s[16:19], s69 offen offset:0 sc1
    buffer_load_dword v29, v26, s[16:19], s69 offen offset:128 sc1
    buffer_load_dword v30, v26, s[16:19], s70 offen offset:0 sc1
    buffer_load_dword v31, v26, s[16:19], s70 offen offset:128 sc1
    v_and_b32 v27, 15, v1
    v_bfe_u32 v32, v1, 4, 1
    v_mul_u32_u24 v32, 1536, v32
    v_add_u32 v27, v27, v32
    v_lshlrev_b32 v27, 2, v27
    s_mul_i32 s69, s28, 384
    s_mul_i32 s70, s81, 192
    s_add_u32 s69, s69, s70
    s_add_u32 s69, s69, 19947008
    buffer_load_dword v228, v27, s[16:19], s69 offen offset:0 sc1
    buffer_load_dword v229, v27, s[16:19], s69 offen offset:64 sc1
    buffer_load_dword v230, v27, s[16:19], s69 offen offset:128 sc1
    s_add_u32 s69, s69, 19968
    buffer_load_dword v233, v27, s[16:19], s69 offen offset:0 sc1
    buffer_load_dword v234, v27, s[16:19], s69 offen offset:64 sc1
    buffer_load_dword v235, v27, s[16:19], s69 offen offset:128 sc1
    s_add_u32 s69, s69, 19968
    buffer_load_dword v238, v27, s[16:19], s69 offen offset:0 sc1
    buffer_load_dword v239, v27, s[16:19], s69 offen offset:64 sc1
    buffer_load_dword v240, v27, s[16:19], s69 offen offset:128 sc1
    s_add_u32 s69, s69, 19968
    buffer_load_dword v243, v27, s[16:19], s69 offen offset:0 sc1
    buffer_load_dword v244, v27, s[16:19], s69 offen offset:64 sc1
    buffer_load_dword v245, v27, s[16:19], s69 offen offset:128 sc1
LGGU_notyet:
    s_waitcnt lgkmcnt(0)
    s_add_u32 s69, s67, 12576
    s_cmp_eq_u32 s69, 62880
    s_cselect_b32 s69, 0, s69
    s_sub_u32 s70, s69, s67
    s_mov_b32 s67, s69
    v_add_u32 v16, s70, v16
    v_mfma_f32_32x32x16_bf16 v[64:79], v[200:203], v[192:195], v[64:79]
    ds_read_b128 v[168:171], v8 offset:0
    ds_read_b128 v[172:175], v8 offset:4096
    v_add_u32 v8, s68, v8
    v_mfma_f32_32x32x16_bf16 v[112:127], v[200:203], v[196:199], v[112:127]
    ds_read_b64_tr_b16 v[176:177], v16 offset:0
    ds_read_b64_tr_b16 v[178:179], v16 offset:768
    v_mfma_f32_32x32x16_bf16 v[80:95], v[204:207], v[192:195], v[80:95]
    ds_read_b64_tr_b16 v[180:181], v16 offset:32
    ds_read_b64_tr_b16 v[182:183], v16 offset:800
    v_mfma_f32_32x32x16_bf16 v[128:143], v[204:207], v[196:199], v[128:143]
    ds_read_b64_tr_b16 v[184:185], v16 offset:64
    ds_read_b64_tr_b16 v[186:187], v16 offset:832
    v_mfma_f32_32x32x16_bf16 v[96:111], v[208:211], v[192:195], v[96:111]
    v_mfma_f32_32x32x16_bf16 v[144:159], v[208:211], v[196:199], v[144:159]
    s_waitcnt lgkmcnt(0)
    v_mfma_f32_32x32x16_bf16 v[64:79], v[176:179], v[168:171], v[64:79]
    ds_read_b128 v[192:195], v9 offset:0
    ds_read_b128 v[196:199], v9 offset:4096
    v_add_u32 v9, s68, v9
    v_mfma_f32_32x32x16_bf16 v[112:127], v[176:179], v[172:175], v[112:127]
    ds_read_b64_tr_b16 v[200:201], v16 offset:3136
    ds_read_b64_tr_b16 v[202:203], v16 offset:3904
    v_mfma_f32_32x32x16_bf16 v[80:95], v[180:183], v[168:171], v[80:95]
    ds_read_b64_tr_b16 v[204:205], v16 offset:3168
    ds_read_b64_tr_b16 v[206:207], v16 offset:3936
    v_mfma_f32_32x32x16_bf16 v[128:143], v[180:183], v[172:175], v[128:143]
    ds_read_b64_tr_b16 v[208:209], v16 offset:3200
    ds_read_b64_tr_b16 v[210:211], v16 offset:3968
    v_mfma_f32_32x32x16_bf16 v[96:111], v[184:187], v[168:171], v[96:111]
    v_mfma_f32_32x32x16_bf16 v[144:159], v[184:187], v[172:175], v[144:159]
    s_waitcnt lgkmcnt(0)
    v_mfma_f32_32x32x16_bf16 v[64:79], v[200:203], v[192:195], v[64:79]
    v_mfma_f32_32x32x16_bf16 v[112:127], v[200:203], v[196:199], v[112:127]
    v_mfma_f32_32x32x16_bf16 v[80:95], v[204:207], v[192:195], v[80:95]
    v_mfma_f32_32x32x16_bf16 v[128:143], v[204:207], v[196:199], v[128:143]
    v_mfma_f32_32x32x16_bf16 v[96:111], v[208:211], v[192:195], v[96:111]
    v_mfma_f32_32x32x16_bf16 v[144:159], v[208:211], v[196:199], v[144:159]
    s_cmp_lg_u32 s78, 0
    s_cbranch_scc1 LGGU_have
LGGU_poll:
    buffer_load_dword v24, v5, s[20:23], 0 offen sc1
    s_waitcnt vmcnt(0)
    v_cmp_eq_u32 vcc, 0, v24
    s_nop 4
    s_cmp_eq_u64 vcc, 0
    s_cbranch_scc1 LGGU_pollok
    s_sleep 1
    s_branch LGGU_poll
LGGU_pollok:
    s_lshl_b32 s76, s27, 8
    s_lshl_b32 s77, s80, 6
    s_add_u32 s76, s76, s77
    v_and_b32 v25, 31, v1
    v_add_u32 v26, s76, v25
    v_lshlrev_b32 v26, 2, v26
    s_mov_b32 s69, 19922944
    s_mov_b32 s70, 19931136
    buffer_load_dword v28, v26, s[16:19], s69 offen offset:0 sc1
    buffer_load_dword v29, v26, s[16:19], s69 offen offset:128 sc1
    buffer_load_dword v30, v26, s[16:19], s70 offen offset:0 sc1
    buffer_load_dword v31, v26, s[16:19], s70 offen offset:128 sc1
    v_and_b32 v27, 15, v1
    v_bfe_u32 v32, v1, 4, 1
    v_mul_u32_u24 v32, 1536, v32
    v_add_u32 v27, v27, v32
    v_lshlrev_b32 v27, 2, v27
    s_mul_i32 s69, s28, 384
    s_mul_i32 s70, s81, 192
    s_add_u32 s69, s69, s70
    s_add_u32 s69, s69, 19947008
    buffer_load_dword v228, v27, s[16:19], s69 offen offset:0 sc1
    buffer_load_dword v229, v27, s[16:19], s69 offen offset:64 sc1
    buffer_load_dword v230, v27, s[16:19], s69 offen offset:128 sc1
    s_add_u32 s69, s69, 19968
    buffer_load_dword v233, v27, s[16:19], s69 offen offset:0 sc1
    buffer_load_dword v234, v27, s[16:19], s69 offen offset:64 sc1
    buffer_load_dword v235, v27, s[16:19], s69 offen offset:128 sc1
    s_add_u32 s69, s69, 19968
    buffer_load_dword v238, v27, s[16:19], s69 offen offset:0 sc1
    buffer_load_dword v239, v27, s[16:19], s69 offen offset:64 sc1
    buffer_load_dword v240, v27, s[16:19], s69 offen offset:128 sc1
    s_add_u32 s69, s69, 19968
    buffer_load_dword v243, v27, s[16:19], s69 offen offset:0 sc1
    buffer_load_dword v244, v27, s[16:19], s69 offen offset:64 sc1
    buffer_load_dword v245, v27, s[16:19], s69 offen offset:128 sc1
LGGU_have:
    s_waitcnt vmcnt(0)
    s_mov_b32 s64, -1
    s_mov_b32 s65, 0
    v_add_f32 v34, v228, v233
    v_add_f32 v238, v238, v243
    v_add_f32 v34, v34, v238
    v_add_f32 v35, v229, v234
    v_add_f32 v239, v239, v244
    v_add_f32 v35, v35, v239
    v_add_f32 v36, v230, v235
    v_add_f32 v240, v240, v245
    v_add_f32 v36, v36, v240
    v_xor_b32 v24, 0x80000000, v28
    v_lshrrev_b32 v25, 16, v24
    v_or_b32 v26, v25, v24
    v_cndmask_b32 v168, 0, v26, s[64:65]
    v_cndmask_b32 v169, 0, v25, s[64:65]
    v_mov_b32 v170, 0
    v_mov_b32 v171, 0
    v_xor_b32 v24, 0x80000000, v29
    v_lshrrev_b32 v25, 16, v24
    v_or_b32 v26, v25, v24
    v_cndmask_b32 v172, 0, v26, s[64:65]
    v_cndmask_b32 v173, 0, v25, s[64:65]
    v_mov_b32 v174, 0
    v_mov_b32 v175, 0
    v_and_b32 v24, 0xffff0000, v34
    v_sub_f32 v25, v34, v24
    v_and_b32 v26, 0xffff0000, v25
    v_sub_f32 v25, v25, v26
    v_lshrrev_b32 v24, 16, v24
    v_or_b32 v216, v24, v26
    v_lshrrev_b32 v217, 16, v25
    v_mov_b32 v218, 0
    v_mov_b32 v219, 0
    v_and_b32 v24, 0xffff0000, v35
    v_sub_f32 v25, v35, v24
    v_and_b32 v26, 0xffff0000, v25
    v_sub_f32 v25, v25, v26
    v_lshrrev_b32 v24, 16, v24
    v_or_b32 v220, v24, v26
    v_lshrrev_b32 v221, 16, v25
    v_mov_b32 v222, 0
    v_mov_b32 v223, 0
    v_mfma_f32_32x32x16_bf16 v[64:79], v[216:219], v[168:171], v[64:79]
    v_mfma_f32_32x32x16_bf16 v[112:127], v[216:219], v[172:175], v[112:127]
    v_and_b32 v24, 0xffff0000, v36
    v_sub_f32 v25, v36, v24
    v_and_b32 v26, 0xffff0000, v25
    v_sub_f32 v25, v25, v26
    v_lshrrev_b32 v24, 16, v24
    v_or_b32 v224, v24, v26
    v_lshrrev_b32 v225, 16, v25
    v_mov_b32 v226, 0
    v_mov_b32 v227, 0
    s_nop 1
    v_mfma_f32_32x32x16_bf16 v[80:95], v[220:223], v[168:171], v[80:95]
    v_mfma_f32_32x32x16_bf16 v[128:143], v[220:223], v[172:175], v[128:143]
    v_mfma_f32_32x32x16_bf16 v[96:111], v[224:227], v[168:171], v[96:111]
    v_mfma_f32_32x32x16_bf16 v[144:159], v[224:227], v[172:175], v[144:159]
    s_lshr_b32 s69, s76, 5
    v_mul_f32 v4, v30, v30
    v_mul_f32 v5, v31, v31
    s_lshl_b32 s71, s69, 1
    s_mul_i32 s71, s71, 69632
    s_mul_i32 s72, s28, 3072
    s_add_u32 s71, s71, s72
    s_mul_i32 s72, s81, 1536
    s_add_u32 s71, s71, s72
    s_add_u32 s71, s71, 7884800
    s_add_u32 s72, s71, 139264
    v_bfe_u32 v2, v1, 4, 1
    v_mul_u32_u24 v2, 69632, v2
    v_and_b32 v3, 15, v1
    v_lshl_add_u32 v2, v3, 4, v2
    v_lshrrev_b32 v3, 5, v1
    v_lshl_add_u32 v2, v3, 8, v2
    s_nop 3
    v_max_f32 v64, 0, v64
    v_mul_f32 v72, v72, v4
    v_mul_f32 v64, v64, v72
    v_max_f32 v65, 0, v65
    v_mul_f32 v73, v73, v4
    v_mul_f32 v65, v65, v73
    v_max_f32 v66, 0, v66
    v_mul_f32 v74, v74, v4
    v_mul_f32 v66, v66, v74
    v_max_f32 v67, 0, v67
    v_mul_f32 v75, v75, v4
    v_mul_f32 v67, v67, v75
    v_max_f32 v68, 0, v68
    v_mul_f32 v76, v76, v4
    v_mul_f32 v68, v68, v76
    v_max_f32 v69, 0, v69
    v_mul_f32 v77, v77, v4
    v_mul_f32 v69, v69, v77
    v_max_f32 v70, 0, v70
    v_mul_f32 v78, v78, v4
    v_mul_f32 v70, v70, v78
    v_max_f32 v71, 0, v71
    v_mul_f32 v79, v79, v4
    v_mul_f32 v71, v71, v79
    v_cvt_pk_bf16_f32 v32, v64, v65
    v_cvt_pk_bf16_f32 v33, v66, v67
    v_cvt_pk_bf16_f32 v34, v68, v69
    v_cvt_pk_bf16_f32 v35, v70, v71
    buffer_store_dwordx4 v[32:35], v2, s[16:19], s71 offen offset:0
    v_max_f32 v112, 0, v112
    v_mul_f32 v120, v120, v5
    v_mul_f32 v112, v112, v120
    v_max_f32 v113, 0, v113
    v_mul_f32 v121, v121, v5
    v_mul_f32 v113, v113, v121
    v_max_f32 v114, 0, v114
    v_mul_f32 v122, v122, v5
    v_mul_f32 v114, v114, v122
    v_max_f32 v115, 0, v115
    v_mul_f32 v123, v123, v5
    v_mul_f32 v115, v115, v123
    v_max_f32 v116, 0, v116
    v_mul_f32 v124, v124, v5
    v_mul_f32 v116, v116, v124
    v_max_f32 v117, 0, v117
    v_mul_f32 v125, v125, v5
    v_mul_f32 v117, v117, v125
    v_max_f32 v118, 0, v118
    v_mul_f32 v126, v126, v5
    v_mul_f32 v118, v118, v126
    v_max_f32 v119, 0, v119
    v_mul_f32 v127, v127, v5
    v_mul_f32 v119, v119, v127
    v_cvt_pk_bf16_f32 v36, v112, v113
    v_cvt_pk_bf16_f32 v37, v114, v115
    v_cvt_pk_bf16_f32 v38, v116, v117
    v_cvt_pk_bf16_f32 v39, v118, v119
    buffer_store_dwordx4 v[36:39], v2, s[16:19], s72 offen offset:0
    v_max_f32 v80, 0, v80
    v_mul_f32 v88, v88, v4
    v_mul_f32 v80, v80, v88
    v_max_f32 v81, 0, v81
    v_mul_f32 v89, v89, v4
    v_mul_f32 v81, v81, v89
    v_max_f32 v82, 0, v82
    v_mul_f32 v90, v90, v4
    v_mul_f32 v82, v82, v90
    v_max_f32 v83, 0, v83
    v_mul_f32 v91, v91, v4
    v_mul_f32 v83, v83, v91
    v_max_f32 v84, 0, v84
    v_mul_f32 v92, v92, v4
    v_mul_f32 v84, v84, v92
    v_max_f32 v85, 0, v85
    v_mul_f32 v93, v93, v4
    v_mul_f32 v85, v85, v93
    v_max_f32 v86, 0, v86
    v_mul_f32 v94, v94, v4
    v_mul_f32 v86, v86, v94
    v_max_f32 v87, 0, v87
    v_mul_f32 v95, v95, v4
    v_mul_f32 v87, v87, v95
    v_cvt_pk_bf16_f32 v40, v80, v81
    v_cvt_pk_bf16_f32 v41, v82, v83
    v_cvt_pk_bf16_f32 v42, v84, v85
    v_cvt_pk_bf16_f32 v43, v86, v87
    buffer_store_dwordx4 v[40:43], v2, s[16:19], s71 offen offset:512
    v_max_f32 v128, 0, v128
    v_mul_f32 v136, v136, v5
    v_mul_f32 v128, v128, v136
    v_max_f32 v129, 0, v129
    v_mul_f32 v137, v137, v5
    v_mul_f32 v129, v129, v137
    v_max_f32 v130, 0, v130
    v_mul_f32 v138, v138, v5
    v_mul_f32 v130, v130, v138
    v_max_f32 v131, 0, v131
    v_mul_f32 v139, v139, v5
    v_mul_f32 v131, v131, v139
    v_max_f32 v132, 0, v132
    v_mul_f32 v140, v140, v5
    v_mul_f32 v132, v132, v140
    v_max_f32 v133, 0, v133
    v_mul_f32 v141, v141, v5
    v_mul_f32 v133, v133, v141
    v_max_f32 v134, 0, v134
    v_mul_f32 v142, v142, v5
    v_mul_f32 v134, v134, v142
    v_max_f32 v135, 0, v135
    v_mul_f32 v143, v143, v5
    v_mul_f32 v135, v135, v143
    v_cvt_pk_bf16_f32 v44, v128, v129
    v_cvt_pk_bf16_f32 v45, v130, v131
    v_cvt_pk_bf16_f32 v46, v132, v133
    v_cvt_pk_bf16_f32 v47, v134, v135
    buffer_store_dwordx4 v[44:47], v2, s[16:19], s72 offen offset:512
    v_max_f32 v96, 0, v96
    v_mul_f32 v104, v104, v4
    v_mul_f32 v96, v96, v104
    v_max_f32 v97, 0, v97
    v_mul_f32 v105, v105, v4
    v_mul_f32 v97, v97, v105
    v_max_f32 v98, 0, v98
    v_mul_f32 v106, v106, v4
    v_mul_f32 v98, v98, v106
    v_max_f32 v99, 0, v99
    v_mul_f32 v107, v107, v4
    v_mul_f32 v99, v99, v107
    v_max_f32 v100, 0, v100
    v_mul_f32 v108, v108, v4
    v_mul_f32 v100, v100, v108
    v_max_f32 v101, 0, v101
    v_mul_f32 v109, v109, v4
    v_mul_f32 v101, v101, v109
    v_max_f32 v102, 0, v102
    v_mul_f32 v110, v110, v4
    v_mul_f32 v102, v102, v110
    v_max_f32 v103, 0, v103
    v_mul_f32 v111, v111, v4
    v_mul_f32 v103, v103, v111
    v_cvt_pk_bf16_f32 v48, v96, v97
    v_cvt_pk_bf16_f32 v49, v98, v99
    v_cvt_pk_bf16_f32 v50, v100, v101
    v_cvt_pk_bf16_f32 v51, v102, v103
    buffer_store_dwordx4 v[48:51], v2, s[16:19], s71 offen offset:1024
    v_max_f32 v144, 0, v144
    v_mul_f32 v152, v152, v5
    v_mul_f32 v144, v144, v152
    v_max_f32 v145, 0, v145
    v_mul_f32 v153, v153, v5
    v_mul_f32 v145, v145, v153
    v_max_f32 v146, 0, v146
    v_mul_f32 v154, v154, v5
    v_mul_f32 v146, v146, v154
    v_max_f32 v147, 0, v147
    v_mul_f32 v155, v155, v5
    v_mul_f32 v147, v147, v155
    v_max_f32 v148, 0, v148
    v_mul_f32 v156, v156, v5
    v_mul_f32 v148, v148, v156
    v_max_f32 v149, 0, v149
    v_mul_f32 v157, v157, v5
    v_mul_f32 v149, v149, v157
    v_max_f32 v150, 0, v150
    v_mul_f32 v158, v158, v5
    v_mul_f32 v150, v150, v158
    v_max_f32 v151, 0, v151
    v_mul_f32 v159, v159, v5
    v_mul_f32 v151, v151, v159
    v_cvt_pk_bf16_f32 v52, v144, v145
    v_cvt_pk_bf16_f32 v53, v146, v147
    v_cvt_pk_bf16_f32 v54, v148, v149
    v_cvt_pk_bf16_f32 v55, v150, v151
    buffer_store_dwordx4 v[52:55], v2, s[16:19], s72 offen offset:1024
    s_endpgm
LP:
    s_waitcnt lgkmcnt(0)
    s_mov_b32 s8, s36
    s_mov_b32 s9, s37
    s_mov_b32 s10, 2621440
    s_mov_b32 s11, 0x00020000
    s_mov_b32 s16, s54
    s_mov_b32 s17, s55
    s_mov_b32 s18, 268435456
    s_mov_b32 s19, 0x00020000
    s_mov_b32 s20, s52
    s_mov_b32 s21, s53
    s_mov_b32 s22, 256
    s_mov_b32 s23, 0x00020000
    v_mov_b32 v2, 160000
    v_mov_b32 v3, 0
    ds_write_b32 v2, v3
    s_lshl_b32 s27, s25, 2
    s_add_u32 s27, s27, s26
    s_waitcnt lgkmcnt(0)
    s_barrier
    s_cmp_ge_u32 s24, 5
    s_cbranch_scc1 LP_st
    s_mul_i32 s30, s27, 5
    s_add_u32 s30, s30, s24
    s_cmp_ge_u32 s30, 156
    s_cbranch_scc1 LP_flag
    s_lshr_b32 s31, s30, 2
    s_and_b32 s30, s30, 3
    s_cmp_lt_u32 s31, 27
    s_cselect_b32 s12, s44, s46
    s_cselect_b32 s13, s45, s47
    s_cselect_b32 s56, 15, 27
    s_mov_b32 s14, 1966080
    s_mov_b32 s60, 3072
    s_cmp_lt_u32 s31, 15
    s_cselect_b32 s12, s38, s12
    s_cselect_b32 s13, s39, s13
    s_cselect_b32 s56, 0, s56
    s_cselect_b32 s14, 2457600, s14
    s_cselect_b32 s60, 3840, s60
    s_mov_b32 s15, 0x00020000
    s_sub_u32 s56, s31, s56
    s_lshl_b32 s57, s56, 8
    s_mul_i32 s61, s30, 160
    v_lshrrev_b32 v6, 4, v1
    v_add_u32 v6, s61, v6
    v_mul_lo_u32 v6, v6, s60
    v_and_b32 v7, 15, v1
    v_lshl_add_u32 v6, v7, 4, v6
    s_lshl_b32 s62, s60, 2
    s_mov_b32 s58, 0x00003f80
    s_mov_b32 s59, 0x3f800000
    s_mov_b32 s61, 0
    v_mov_b32 v16, 0
    v_mov_b32 v17, 0
    v_mov_b32 v18, 0
    v_mov_b32 v19, 0
    v_mov_b32 v20, 0
    v_mov_b32 v21, 0
    v_mov_b32 v22, 0
    v_mov_b32 v23, 0
    buffer_load_dwordx4 v[48:51], v6, s[12:15], s57 offen
    s_add_u32 s57, s57, s62
    buffer_load_dwordx4 v[52:55], v6, s[12:15], s57 offen
    s_add_u32 s57, s57, s62
    buffer_load_dwordx4 v[56:59], v6, s[12:15], s57 offen
    s_add_u32 s57, s57, s62
    buffer_load_dwordx4 v[60:63], v6, s[12:15], s57 offen
    s_add_u32 s57, s57, s62
    buffer_load_dwordx4 v[64:67], v6, s[12:15], s57 offen
    s_add_u32 s57, s57, s62
    buffer_load_dwordx4 v[68:71], v6, s[12:15], s57 offen
    s_add_u32 s57, s57, s62
    buffer_load_dwordx4 v[72:75], v6, s[12:15], s57 offen
    s_add_u32 s57, s57, s62
    buffer_load_dwordx4 v[76:79], v6, s[12:15], s57 offen
    s_add_u32 s57, s57, s62
    buffer_load_dwordx4 v[80:83], v6, s[12:15], s57 offen
    s_add_u32 s57, s57, s62
    buffer_load_dwordx4 v[84:87], v6, s[12:15], s57 offen
    s_add_u32 s57, s57, s62
    buffer_load_dwordx4 v[88:91], v6, s[12:15], s57 offen
    s_add_u32 s57, s57, s62
    buffer_load_dwordx4 v[92:95], v6, s[12:15], s57 offen
    s_add_u32 s57, s57, s62
    buffer_load_dwordx4 v[96:99], v6, s[12:15], s57 offen
    s_add_u32 s57, s57, s62
    buffer_load_dwordx4 v[100:103], v6, s[12:15], s57 offen
    s_add_u32 s57, s57, s62
    buffer_load_dwordx4 v[104:107], v6, s[12:15], s57 offen
    s_add_u32 s57, s57, s62
    buffer_load_dwordx4 v[108:111], v6, s[12:15], s57 offen
    s_add_u32 s57, s57, s62
    buffer_load_dwordx4 v[112:115], v6, s[12:15], s57 offen
    s_add_u32 s57, s57, s62
    buffer_load_dwordx4 v[116:119], v6, s[12:15], s57 offen
    s_add_u32 s57, s57, s62
    buffer_load_dwordx4 v[120:123], v6, s[12:15], s57 offen
    s_add_u32 s57, s57, s62
    buffer_load_dwordx4 v[124:127], v6, s[12:15], s57 offen
    s_add_u32 s57, s57, s62
    buffer_load_dwordx4 v[128:131], v6, s[12:15], s57 offen
    s_add_u32 s57, s57, s62
    buffer_load_dwordx4 v[132:135], v6, s[12:15], s57 offen
    s_add_u32 s57, s57, s62
    buffer_load_dwordx4 v[136:139], v6, s[12:15], s57 offen
    s_add_u32 s57, s57, s62
    buffer_load_dwordx4 v[140:143], v6, s[12:15], s57 offen
    s_add_u32 s57, s57, s62
    buffer_load_dwordx4 v[144:147], v6, s[12:15], s57 offen
    s_add_u32 s57, s57, s62
    buffer_load_dwordx4 v[148:151], v6, s[12:15], s57 offen
    s_add_u32 s57, s57, s62
    buffer_load_dwordx4 v[152:155], v6, s[12:15], s57 offen
    s_add_u32 s57, s57, s62
    buffer_load_dwordx4 v[156:159], v6, s[12:15], s57 offen
    s_add_u32 s57, s57, s62
    buffer_load_dwordx4 v[160:163], v6, s[12:15], s57 offen
    s_add_u32 s57, s57, s62
    buffer_load_dwordx4 v[164:167], v6, s[12:15], s57 offen
    s_add_u32 s57, s57, s62
    buffer_load_dwordx4 v[168:171], v6, s[12:15], s57 offen
    s_add_u32 s57, s57, s62
    buffer_load_dwordx4 v[172:175], v6, s[12:15], s57 offen
    s_add_u32 s57, s57, s62
    buffer_load_dwordx4 v[176:179], v6, s[12:15], s57 offen
    s_add_u32 s57, s57, s62
    buffer_load_dwordx4 v[180:183], v6, s[12:15], s57 offen
    s_add_u32 s57, s57, s62
    buffer_load_dwordx4 v[184:187], v6, s[12:15], s57 offen
    s_add_u32 s57, s57, s62
    buffer_load_dwordx4 v[188:191], v6, s[12:15], s57 offen
    s_add_u32 s57, s57, s62
    buffer_load_dwordx4 v[192:195], v6, s[12:15], s57 offen
    s_add_u32 s57, s57, s62
    buffer_load_dwordx4 v[196:199], v6, s[12:15], s57 offen
    s_add_u32 s57, s57, s62
    buffer_load_dwordx4 v[200:203], v6, s[12:15], s57 offen
    s_add_u32 s57, s57, s62
    buffer_load_dwordx4 v[204:207], v6, s[12:15], s57 offen
    s_add_u32 s57, s57, s62
LP_csl:
    s_waitcnt vmcnt(35)
    v_dot2c_f32_bf16 v16, s58, v48
    v_dot2c_f32_bf16 v17, s59, v48
    v_dot2c_f32_bf16 v18, s58, v49
    v_dot2c_f32_bf16 v19, s59, v49
    v_dot2c_f32_bf16 v20, s58, v50
    v_dot2c_f32_bf16 v21, s59, v50
    v_dot2c_f32_bf16 v22, s58, v51
    v_dot2c_f32_bf16 v23, s59, v51
    v_dot2c_f32_bf16 v16, s58, v52
    v_dot2c_f32_bf16 v17, s59, v52
    v_dot2c_f32_bf16 v18, s58, v53
    v_dot2c_f32_bf16 v19, s59, v53
    v_dot2c_f32_bf16 v20, s58, v54
    v_dot2c_f32_bf16 v21, s59, v54
    v_dot2c_f32_bf16 v22, s58, v55
    v_dot2c_f32_bf16 v23, s59, v55
    v_dot2c_f32_bf16 v16, s58, v56
    v_dot2c_f32_bf16 v17, s59, v56
    v_dot2c_f32_bf16 v18, s58, v57
    v_dot2c_f32_bf16 v19, s59, v57
    v_dot2c_f32_bf16 v20, s58, v58
    v_dot2c_f32_bf16 v21, s59, v58
    v_dot2c_f32_bf16 v22, s58, v59
    v_dot2c_f32_bf16 v23, s59, v59
    v_dot2c_f32_bf16 v16, s58, v60
    v_dot2c_f32_bf16 v17, s59, v60
    v_dot2c_f32_bf16 v18, s58, v61
    v_dot2c_f32_bf16 v19, s59, v61
    v_dot2c_f32_bf16 v20, s58, v62
    v_dot2c_f32_bf16 v21, s59, v62
    v_dot2c_f32_bf16 v22, s58, v63
    v_dot2c_f32_bf16 v23, s59, v63
    v_dot2c_f32_bf16 v16, s58, v64
    v_dot2c_f32_bf16 v17, s59, v64
    v_dot2c_f32_bf16 v18, s58, v65
    v_dot2c_f32_bf16 v19, s59, v65
    v_dot2c_f32_bf16 v20, s58, v66
    v_dot2c_f32_bf16 v21, s59, v66
    v_dot2c_f32_bf16 v22, s58, v67
    v_dot2c_f32_bf16 v23, s59, v67
    s_waitcnt vmcnt(30)
    v_dot2c_f32_bf16 v16, s58, v68
    v_dot2c_f32_bf16 v17, s59, v68
    v_dot2c_f32_bf16 v18, s58, v69
    v_dot2c_f32_bf16 v19, s59, v69
    v_dot2c_f32_bf16 v20, s58, v70
    v_dot2c_f32_bf16 v21, s59, v70
    v_dot2c_f32_bf16 v22, s58, v71
    v_dot2c_f32_bf16 v23, s59, v71
    v_dot2c_f32_bf16 v16, s58, v72
    v_dot2c_f32_bf16 v17, s59, v72
    v_dot2c_f32_bf16 v18, s58, v73
    v_dot2c_f32_bf16 v19, s59, v73
    v_dot2c_f32_bf16 v20, s58, v74
    v_dot2c_f32_bf16 v21, s59, v74
    v_dot2c_f32_bf16 v22, s58, v75
    v_dot2c_f32_bf16 v23, s59, v75
    v_dot2c_f32_bf16 v16, s58, v76
    v_dot2c_f32_bf16 v17, s59, v76
    v_dot2c_f32_bf16 v18, s58, v77
    v_dot2c_f32_bf16 v19, s59, v77
    v_dot2c_f32_bf16 v20, s58, v78
    v_dot2c_f32_bf16 v21, s59, v78
    v_dot2c_f32_bf16 v22, s58, v79
    v_dot2c_f32_bf16 v23, s59, v79
    v_dot2c_f32_bf16 v16, s58, v80
    v_dot2c_f32_bf16 v17, s59, v80
    v_dot2c_f32_bf16 v18, s58, v81
    v_dot2c_f32_bf16 v19, s59, v81
    v_dot2c_f32_bf16 v20, s58, v82
    v_dot2c_f32_bf16 v21, s59, v82
    v_dot2c_f32_bf16 v22, s58, v83
    v_dot2c_f32_bf16 v23, s59, v83
    v_dot2c_f32_bf16 v16, s58, v84
    v_dot2c_f32_bf16 v17, s59, v84
    v_dot2c_f32_bf16 v18, s58, v85
    v_dot2c_f32_bf16 v19, s59, v85
    v_dot2c_f32_bf16 v20, s58, v86
    v_dot2c_f32_bf16 v21, s59, v86
    v_dot2c_f32_bf16 v22, s58, v87
    v_dot2c_f32_bf16 v23, s59, v87
    s_waitcnt vmcnt(25)
    v_dot2c_f32_bf16 v16, s58, v88
    v_dot2c_f32_bf16 v17, s59, v88
    v_dot2c_f32_bf16 v18, s58, v89
    v_dot2c_f32_bf16 v19, s59, v89
    v_dot2c_f32_bf16 v20, s58, v90
    v_dot2c_f32_bf16 v21, s59, v90
    v_dot2c_f32_bf16 v22, s58, v91
    v_dot2c_f32_bf16 v23, s59, v91
    v_dot2c_f32_bf16 v16, s58, v92
    v_dot2c_f32_bf16 v17, s59, v92
    v_dot2c_f32_bf16 v18, s58, v93
    v_dot2c_f32_bf16 v19, s59, v93
    v_dot2c_f32_bf16 v20, s58, v94
    v_dot2c_f32_bf16 v21, s59, v94
    v_dot2c_f32_bf16 v22, s58, v95
    v_dot2c_f32_bf16 v23, s59, v95
    v_dot2c_f32_bf16 v16, s58, v96
    v_dot2c_f32_bf16 v17, s59, v96
    v_dot2c_f32_bf16 v18, s58, v97
    v_dot2c_f32_bf16 v19, s59, v97
    v_dot2c_f32_bf16 v20, s58, v98
    v_dot2c_f32_bf16 v21, s59, v98
    v_dot2c_f32_bf16 v22, s58, v99
    v_dot2c_f32_bf16 v23, s59, v99
    v_dot2c_f32_bf16 v16, s58, v100
    v_dot2c_f32_bf16 v17, s59, v100
    v_dot2c_f32_bf16 v18, s58, v101
    v_dot2c_f32_bf16 v19, s59, v101
    v_dot2c_f32_bf16 v20, s58, v102
    v_dot2c_f32_bf16 v21, s59, v102
    v_dot2c_f32_bf16 v22, s58, v103
    v_dot2c_f32_bf16 v23, s59, v103
    v_dot2c_f32_bf16 v16, s58, v104
    v_dot2c_f32_bf16 v17, s59, v104
    v_dot2c_f32_bf16 v18, s58, v105
    v_dot2c_f32_bf16 v19, s59, v105
    v_dot2c_f32_bf16 v20, s58, v106
    v_dot2c_f32_bf16 v21, s59, v106
    v_dot2c_f32_bf16 v22, s58, v107
    v_dot2c_f32_bf16 v23, s59, v107
    s_waitcnt vmcnt(20)
    v_dot2c_f32_bf16 v16, s58, v108
    v_dot2c_f32_bf16 v17, s59, v108
    v_dot2c_f32_bf16 v18, s58, v109
    v_dot2c_f32_bf16 v19, s59, v109
    v_dot2c_f32_bf16 v20, s58, v110
    v_dot2c_f32_bf16 v21, s59, v110
    v_dot2c_f32_bf16 v22, s58, v111
    v_dot2c_f32_bf16 v23, s59, v111
    v_dot2c_f32_bf16 v16, s58, v112
    v_dot2c_f32_bf16 v17, s59, v112
    v_dot2c_f32_bf16 v18, s58, v113
    v_dot2c_f32_bf16 v19, s59, v113
    v_dot2c_f32_bf16 v20, s58, v114
    v_dot2c_f32_bf16 v21, s59, v114
    v_dot2c_f32_bf16 v22, s58, v115
    v_dot2c_f32_bf16 v23, s59, v115
    v_dot2c_f32_bf16 v16, s58, v116
    v_dot2c_f32_bf16 v17, s59, v116
    v_dot2c_f32_bf16 v18, s58, v117
    v_dot2c_f32_bf16 v19, s59, v117
    v_dot2c_f32_bf16 v20, s58, v118
    v_dot2c_f32_bf16 v21, s59, v118
    v_dot2c_f32_bf16 v22, s58, v119
    v_dot2c_f32_bf16 v23, s59, v119
    v_dot2c_f32_bf16 v16, s58, v120
    v_dot2c_f32_bf16 v17, s59, v120
    v_dot2c_f32_bf16 v18, s58, v121
    v_dot2c_f32_bf16 v19, s59, v121
    v_dot2c_f32_bf16 v20, s58, v122
    v_dot2c_f32_bf16 v21, s59, v122
    v_dot2c_f32_bf16 v22, s58, v123
    v_dot2c_f32_bf16 v23, s59, v123
    v_dot2c_f32_bf16 v16, s58, v124
    v_dot2c_f32_bf16 v17, s59, v124
    v_dot2c_f32_bf16 v18, s58, v125
    v_dot2c_f32_bf16 v19, s59, v125
    v_dot2c_f32_bf16 v20, s58, v126
    v_dot2c_f32_bf16 v21, s59, v126
    v_dot2c_f32_bf16 v22, s58, v127
    v_dot2c_f32_bf16 v23, s59, v127
    s_waitcnt vmcnt(15)
    v_dot2c_f32_bf16 v16, s58, v128
    v_dot2c_f32_bf16 v17, s59, v128
    v_dot2c_f32_bf16 v18, s58, v129
    v_dot2c_f32_bf16 v19, s59, v129
    v_dot2c_f32_bf16 v20, s58, v130
    v_dot2c_f32_bf16 v21, s59, v130
    v_dot2c_f32_bf16 v22, s58, v131
    v_dot2c_f32_bf16 v23, s59, v131
    v_dot2c_f32_bf16 v16, s58, v132
    v_dot2c_f32_bf16 v17, s59, v132
    v_dot2c_f32_bf16 v18, s58, v133
    v_dot2c_f32_bf16 v19, s59, v133
    v_dot2c_f32_bf16 v20, s58, v134
    v_dot2c_f32_bf16 v21, s59, v134
    v_dot2c_f32_bf16 v22, s58, v135
    v_dot2c_f32_bf16 v23, s59, v135
    v_dot2c_f32_bf16 v16, s58, v136
    v_dot2c_f32_bf16 v17, s59, v136
    v_dot2c_f32_bf16 v18, s58, v137
    v_dot2c_f32_bf16 v19, s59, v137
    v_dot2c_f32_bf16 v20, s58, v138
    v_dot2c_f32_bf16 v21, s59, v138
    v_dot2c_f32_bf16 v22, s58, v139
    v_dot2c_f32_bf16 v23, s59, v139
    v_dot2c_f32_bf16 v16, s58, v140
    v_dot2c_f32_bf16 v17, s59, v140
    v_dot2c_f32_bf16 v18, s58, v141
    v_dot2c_f32_bf16 v19, s59, v141
    v_dot2c_f32_bf16 v20, s58, v142
    v_dot2c_f32_bf16 v21, s59, v142
    v_dot2c_f32_bf16 v22, s58, v143
    v_dot2c_f32_bf16 v23, s59, v143
    v_dot2c_f32_bf16 v16, s58, v144
    v_dot2c_f32_bf16 v17, s59, v144
    v_dot2c_f32_bf16 v18, s58, v145
    v_dot2c_f32_bf16 v19, s59, v145
    v_dot2c_f32_bf16 v20, s58, v146
    v_dot2c_f32_bf16 v21, s59, v146
    v_dot2c_f32_bf16 v22, s58, v147
    v_dot2c_f32_bf16 v23, s59, v147
    s_waitcnt vmcnt(10)
    v_dot2c_f32_bf16 v16, s58, v148
    v_dot2c_f32_bf16 v17, s59, v148
    v_dot2c_f32_bf16 v18, s58, v149
    v_dot2c_f32_bf16 v19, s59, v149
    v_dot2c_f32_bf16 v20, s58, v150
    v_dot2c_f32_bf16 v21, s59, v150
    v_dot2c_f32_bf16 v22, s58, v151
    v_dot2c_f32_bf16 v23, s59, v151
    v_dot2c_f32_bf16 v16, s58, v152
    v_dot2c_f32_bf16 v17, s59, v152
    v_dot2c_f32_bf16 v18, s58, v153
    v_dot2c_f32_bf16 v19, s59, v153
    v_dot2c_f32_bf16 v20, s58, v154
    v_dot2c_f32_bf16 v21, s59, v154
    v_dot2c_f32_bf16 v22, s58, v155
    v_dot2c_f32_bf16 v23, s59, v155
    v_dot2c_f32_bf16 v16, s58, v156
    v_dot2c_f32_bf16 v17, s59, v156
    v_dot2c_f32_bf16 v18, s58, v157
    v_dot2c_f32_bf16 v19, s59, v157
    v_dot2c_f32_bf16 v20, s58, v158
    v_dot2c_f32_bf16 v21, s59, v158
    v_dot2c_f32_bf16 v22, s58, v159
    v_dot2c_f32_bf16 v23, s59, v159
    v_dot2c_f32_bf16 v16, s58, v160
    v_dot2c_f32_bf16 v17, s59, v160
    v_dot2c_f32_bf16 v18, s58, v161
    v_dot2c_f32_bf16 v19, s59, v161
    v_dot2c_f32_bf16 v20, s58, v162
    v_dot2c_f32_bf16 v21, s59, v162
    v_dot2c_f32_bf16 v22, s58, v163
    v_dot2c_f32_bf16 v23, s59, v163
    v_dot2c_f32_bf16 v16, s58, v164
    v_dot2c_f32_bf16 v17, s59, v164
    v_dot2c_f32_bf16 v18, s58, v165
    v_dot2c_f32_bf16 v19, s59, v165
    v_dot2c_f32_bf16 v20, s58, v166
    v_dot2c_f32_bf16 v21, s59, v166
    v_dot2c_f32_bf16 v22, s58, v167
    v_dot2c_f32_bf16 v23, s59, v167
    s_waitcnt vmcnt(5)
    v_dot2c_f32_bf16 v16, s58, v168
    v_dot2c_f32_bf16 v17, s59, v168
    v_dot2c_f32_bf16 v18, s58, v169
    v_dot2c_f32_bf16 v19, s59, v169
    v_dot2c_f32_bf16 v20, s58, v170
    v_dot2c_f32_bf16 v21, s59, v170
    v_dot2c_f32_bf16 v22, s58, v171
    v_dot2c_f32_bf16 v23, s59, v171
    v_dot2c_f32_bf16 v16, s58, v172
    v_dot2c_f32_bf16 v17, s59, v172
    v_dot2c_f32_bf16 v18, s58, v173
    v_dot2c_f32_bf16 v19, s59, v173
    v_dot2c_f32_bf16 v20, s58, v174
    v_dot2c_f32_bf16 v21, s59, v174
    v_dot2c_f32_bf16 v22, s58, v175
    v_dot2c_f32_bf16 v23, s59, v175
    v_dot2c_f32_bf16 v16, s58, v176
    v_dot2c_f32_bf16 v17, s59, v176
    v_dot2c_f32_bf16 v18, s58, v177
    v_dot2c_f32_bf16 v19, s59, v177
    v_dot2c_f32_bf16 v20, s58, v178
    v_dot2c_f32_bf16 v21, s59, v178
    v_dot2c_f32_bf16 v22, s58, v179
    v_dot2c_f32_bf16 v23, s59, v179
    v_dot2c_f32_bf16 v16, s58, v180
    v_dot2c_f32_bf16 v17, s59, v180
    v_dot2c_f32_bf16 v18, s58, v181
    v_dot2c_f32_bf16 v19, s59, v181
    v_dot2c_f32_bf16 v20, s58, v182
    v_dot2c_f32_bf16 v21, s59, v182
    v_dot2c_f32_bf16 v22, s58, v183
    v_dot2c_f32_bf16 v23, s59, v183
    v_dot2c_f32_bf16 v16, s58, v184
    v_dot2c_f32_bf16 v17, s59, v184
    v_dot2c_f32_bf16 v18, s58, v185
    v_dot2c_f32_bf16 v19, s59, v185
    v_dot2c_f32_bf16 v20, s58, v186
    v_dot2c_f32_bf16 v21, s59, v186
    v_dot2c_f32_bf16 v22, s58, v187
    v_dot2c_f32_bf16 v23, s59, v187
    s_waitcnt vmcnt(0)
    v_dot2c_f32_bf16 v16, s58, v188
    v_dot2c_f32_bf16 v17, s59, v188
    v_dot2c_f32_bf16 v18, s58, v189
    v_dot2c_f32_bf16 v19, s59, v189
    v_dot2c_f32_bf16 v20, s58, v190
    v_dot2c_f32_bf16 v21, s59, v190
    v_dot2c_f32_bf16 v22, s58, v191
    v_dot2c_f32_bf16 v23, s59, v191
    v_dot2c_f32_bf16 v16, s58, v192
    v_dot2c_f32_bf16 v17, s59, v192
    v_dot2c_f32_bf16 v18, s58, v193
    v_dot2c_f32_bf16 v19, s59, v193
    v_dot2c_f32_bf16 v20, s58, v194
    v_dot2c_f32_bf16 v21, s59, v194
    v_dot2c_f32_bf16 v22, s58, v195
    v_dot2c_f32_bf16 v23, s59, v195
    v_dot2c_f32_bf16 v16, s58, v196
    v_dot2c_f32_bf16 v17, s59, v196
    v_dot2c_f32_bf16 v18, s58, v197
    v_dot2c_f32_bf16 v19, s59, v197
    v_dot2c_f32_bf16 v20, s58, v198
    v_dot2c_f32_bf16 v21, s59, v198
    v_dot2c_f32_bf16 v22, s58, v199
    v_dot2c_f32_bf16 v23, s59, v199
    v_dot2c_f32_bf16 v16, s58, v200
    v_dot2c_f32_bf16 v17, s59, v200
    v_dot2c_f32_bf16 v18, s58, v201
    v_dot2c_f32_bf16 v19, s59, v201
    v_dot2c_f32_bf16 v20, s58, v202
    v_dot2c_f32_bf16 v21, s59, v202
    v_dot2c_f32_bf16 v22, s58, v203
    v_dot2c_f32_bf16 v23, s59, v203
    v_dot2c_f32_bf16 v16, s58, v204
    v_dot2c_f32_bf16 v17, s59, v204
    v_dot2c_f32_bf16 v18, s58, v205
    v_dot2c_f32_bf16 v19, s59, v205
    v_dot2c_f32_bf16 v20, s58, v206
    v_dot2c_f32_bf16 v21, s59, v206
    v_dot2c_f32_bf16 v22, s58, v207
    v_dot2c_f32_bf16 v23, s59, v207
    s_nop 2
    ds_swizzle_b32 v24, v16 offset:0x401F
    ds_swizzle_b32 v25, v17 offset:0x401F
    ds_swizzle_b32 v26, v18 offset:0x401F
    ds_swizzle_b32 v27, v19 offset:0x401F
    ds_swizzle_b32 v28, v20 offset:0x401F
    ds_swizzle_b32 v29, v21 offset:0x401F
    ds_swizzle_b32 v30, v22 offset:0x401F
    ds_swizzle_b32 v31, v23 offset:0x401F
    s_waitcnt lgkmcnt(0)
    v_add_f32 v16, v16, v24
    v_mov_b32 v24, v16
    v_add_f32 v17, v17, v25
    v_mov_b32 v25, v17
    v_add_f32 v18, v18, v26
    v_mov_b32 v26, v18
    v_add_f32 v19, v19, v27
    v_mov_b32 v27, v19
    v_add_f32 v20, v20, v28
    v_mov_b32 v28, v20
    v_add_f32 v21, v21, v29
    v_mov_b32 v29, v21
    v_add_f32 v22, v22, v30
    v_mov_b32 v30, v22
    v_add_f32 v23, v23, v31
    v_mov_b32 v31, v23
    s_nop 1
    v_permlane32_swap_b32 v16, v24
    v_permlane32_swap_b32 v17, v25
    v_permlane32_swap_b32 v18, v26
    v_permlane32_swap_b32 v19, v27
    v_permlane32_swap_b32 v20, v28
    v_permlane32_swap_b32 v21, v29
    v_permlane32_swap_b32 v22, v30
    v_permlane32_swap_b32 v23, v31
    s_nop 1
    v_add_f32 v16, v16, v24
    v_add_f32 v17, v17, v25
    v_add_f32 v18, v18, v26
    v_add_f32 v19, v19, v27
    v_add_f32 v20, v20, v28
    v_add_f32 v21, v21, v29
    v_add_f32 v22, v22, v30
    v_add_f32 v23, v23, v31
    s_mul_i32 s58, s30, 19968
    s_lshl_b32 s59, s31, 9
    s_add_u32 s58, s58, s59
    s_add_u32 s58, s58, 19939328
    v_lshlrev_b32 v7, 5, v7
    s_mov_b64 exec, 0xffff
    buffer_store_dwordx4 v[16:19], v7, s[16:19], s58 offen sc1
    buffer_store_dwordx4 v[20:23], v7, s[16:19], s58 offen offset:16 sc1
    s_mov_b64 exec, -1
    s_branch LP_flag
LP_st:
    s_cmp_eq_u32 s24, 7
    s_cbranch_scc0 LP_st2
    s_getpc_b64 s[56:57]
LPC_ref:
    s_sub_u32 s12, s56, LPC_ref-k1_kernel
    s_subb_u32 s13, s57, 0
    s_mov_b32 s14, LCODE_END-k1_kernel
    s_mov_b32 s15, 0x00020000
    s_mul_i32 s58, s26, 12288
    v_lshlrev_b32 v5, 4, v1
    buffer_load_dwordx4 v[200:203], v5, s[12:15], s58 offen offset:0
    buffer_load_dwordx4 v[200:203], v5, s[12:15], s58 offen offset:1024
    buffer_load_dwordx4 v[200:203], v5, s[12:15], s58 offen offset:2048
    buffer_load_dwordx4 v[200:203], v5, s[12:15], s58 offen offset:3072
    s_add_u32 s58, s58, 4096
    buffer_load_dwordx4 v[200:203], v5, s[12:15], s58 offen offset:0
    buffer_load_dwordx4 v[200:203], v5, s[12:15], s58 offen offset:1024
    buffer_load_dwordx4 v[200:203], v5, s[12:15], s58 offen offset:2048
    buffer_load_dwordx4 v[200:203], v5, s[12:15], s58 offen offset:3072
    s_add_u32 s58, s58, 4096
    buffer_load_dwordx4 v[200:203], v5, s[12:15], s58 offen offset:0
    buffer_load_dwordx4 v[200:203], v5, s[12:15], s58 offen offset:1024
    buffer_load_dwordx4 v[200:203], v5, s[12:15], s58 offen offset:2048
    buffer_load_dwordx4 v[200:203], v5, s[12:15], s58 offen offset:3072
    s_branch LP_tr
LP_st2:
    s_lshl_b32 s28, s27, 6
    s_sub_u32 s29, s24, 5
    s_lshl_b32 s29, s29, 5
    s_add_u32 s28, s28, s29
    v_lshrrev_b32 v2, 3, v1
    v_add_u32 v2, s28, v2
    v_mul_u32_u24 v3, 1280, v2
    v_and_b32 v4, 7, v1
    v_lshl_add_u32 v3, v4, 4, v3
    s_mov_b32 s57, 0
    buffer_load_dwordx4 v[48:51], v3, s[8:11], s57 offen offset:0
    buffer_load_dwordx4 v[52:55], v3, s[8:11], s57 offen offset:128
    buffer_load_dwordx4 v[56:59], v3, s[8:11], s57 offen offset:256
    buffer_load_dwordx4 v[60:63], v3, s[8:11], s57 offen offset:384
    buffer_load_dwordx4 v[64:67], v3, s[8:11], s57 offen offset:512
    buffer_load_dwordx4 v[68:71], v3, s[8:11], s57 offen offset:640
    buffer_load_dwordx4 v[72:75], v3, s[8:11], s57 offen offset:768
    buffer_load_dwordx4 v[76:79], v3, s[8:11], s57 offen offset:896
    buffer_load_dwordx4 v[80:83], v3, s[8:11], s57 offen offset:1024
    buffer_load_dwordx4 v[84:87], v3, s[8:11], s57 offen offset:1152
    s_add_u32 s57, s57, 10240
    buffer_load_dwordx4 v[88:91], v3, s[8:11], s57 offen offset:0
    buffer_load_dwordx4 v[92:95], v3, s[8:11], s57 offen offset:128
    buffer_load_dwordx4 v[96:99], v3, s[8:11], s57 offen offset:256
    buffer_load_dwordx4 v[100:103], v3, s[8:11], s57 offen offset:384
    buffer_load_dwordx4 v[104:107], v3, s[8:11], s57 offen offset:512
    buffer_load_dwordx4 v[108:111], v3, s[8:11], s57 offen offset:640
    buffer_load_dwordx4 v[112:115], v3, s[8:11], s57 offen offset:768
    buffer_load_dwordx4 v[116:119], v3, s[8:11], s57 offen offset:896
    buffer_load_dwordx4 v[120:123], v3, s[8:11], s57 offen offset:1024
    buffer_load_dwordx4 v[124:127], v3, s[8:11], s57 offen offset:1152
    s_add_u32 s57, s57, 10240
    buffer_load_dwordx4 v[128:131], v3, s[8:11], s57 offen offset:0
    buffer_load_dwordx4 v[132:135], v3, s[8:11], s57 offen offset:128
    buffer_load_dwordx4 v[136:139], v3, s[8:11], s57 offen offset:256
    buffer_load_dwordx4 v[140:143], v3, s[8:11], s57 offen offset:384
    buffer_load_dwordx4 v[144:147], v3, s[8:11], s57 offen offset:512
    buffer_load_dwordx4 v[148:151], v3, s[8:11], s57 offen offset:640
    buffer_load_dwordx4 v[152:155], v3, s[8:11], s57 offen offset:768
    buffer_load_dwordx4 v[156:159], v3, s[8:11], s57 offen offset:896
    buffer_load_dwordx4 v[160:163], v3, s[8:11], s57 offen offset:1024
    buffer_load_dwordx4 v[164:167], v3, s[8:11], s57 offen offset:1152
    s_add_u32 s57, s57, 10240
    buffer_load_dwordx4 v[168:171], v3, s[8:11], s57 offen offset:0
    buffer_load_dwordx4 v[172:175], v3, s[8:11], s57 offen offset:128
    buffer_load_dwordx4 v[176:179], v3, s[8:11], s57 offen offset:256
    buffer_load_dwordx4 v[180:183], v3, s[8:11], s57 offen offset:384
    buffer_load_dwordx4 v[184:187], v3, s[8:11], s57 offen offset:512
    buffer_load_dwordx4 v[188:191], v3, s[8:11], s57 offen offset:640
    buffer_load_dwordx4 v[192:195], v3, s[8:11], s57 offen offset:768
    buffer_load_dwordx4 v[196:199], v3, s[8:11], s57 offen offset:896
    buffer_load_dwordx4 v[200:203], v3, s[8:11], s57 offen offset:1024
    buffer_load_dwordx4 v[204:207], v3, s[8:11], s57 offen offset:1152
    s_add_u32 s57, s57, 10240
    s_mov_b32 s58, 0x3f803f80
    v_lshlrev_b32 v2, 2, v2
    v_cmp_eq_u32 vcc, 0, v4
    s_mov_b32 s32, 19922944
    s_mov_b32 s33, 19931136
    s_mov_b64 s[34:35], vcc
    v_mov_b32 v16, 0
    v_mov_b32 v17, 0
    v_mov_b32 v18, 0
    v_mov_b32 v19, 0
    v_mov_b32 v20, 0
    v_mov_b32 v21, 0
    v_mov_b32 v22, 0
    v_mov_b32 v23, 0
    s_waitcnt vmcnt(35)
    v_dot2c_f32_bf16 v16, s58, v48
    v_dot2c_f32_bf16 v17, v48, v48
    v_dot2c_f32_bf16 v16, s58, v49
    v_dot2c_f32_bf16 v17, v49, v49
    v_dot2c_f32_bf16 v16, s58, v50
    v_dot2c_f32_bf16 v17, v50, v50
    v_dot2c_f32_bf16 v16, s58, v51
    v_dot2c_f32_bf16 v17, v51, v51
    v_dot2c_f32_bf16 v16, s58, v52
    v_dot2c_f32_bf16 v17, v52, v52
    v_dot2c_f32_bf16 v16, s58, v53
    v_dot2c_f32_bf16 v17, v53, v53
    v_dot2c_f32_bf16 v16, s58, v54
    v_dot2c_f32_bf16 v17, v54, v54
    v_dot2c_f32_bf16 v16, s58, v55
    v_dot2c_f32_bf16 v17, v55, v55
    v_dot2c_f32_bf16 v16, s58, v56
    v_dot2c_f32_bf16 v17, v56, v56
    v_dot2c_f32_bf16 v16, s58, v57
    v_dot2c_f32_bf16 v17, v57, v57
    v_dot2c_f32_bf16 v16, s58, v58
    v_dot2c_f32_bf16 v17, v58, v58
    v_dot2c_f32_bf16 v16, s58, v59
    v_dot2c_f32_bf16 v17, v59, v59
    v_dot2c_f32_bf16 v16, s58, v60
    v_dot2c_f32_bf16 v17, v60, v60
    v_dot2c_f32_bf16 v16, s58, v61
    v_dot2c_f32_bf16 v17, v61, v61
    v_dot2c_f32_bf16 v16, s58, v62
    v_dot2c_f32_bf16 v17, v62, v62
    v_dot2c_f32_bf16 v16, s58, v63
    v_dot2c_f32_bf16 v17, v63, v63
    v_dot2c_f32_bf16 v16, s58, v64
    v_dot2c_f32_bf16 v17, v64, v64
    v_dot2c_f32_bf16 v16, s58, v65
    v_dot2c_f32_bf16 v17, v65, v65
    v_dot2c_f32_bf16 v16, s58, v66
    v_dot2c_f32_bf16 v17, v66, v66
    v_dot2c_f32_bf16 v16, s58, v67
    v_dot2c_f32_bf16 v17, v67, v67
    s_waitcnt vmcnt(30)
    v_dot2c_f32_bf16 v16, s58, v68
    v_dot2c_f32_bf16 v17, v68, v68
    v_dot2c_f32_bf16 v16, s58, v69
    v_dot2c_f32_bf16 v17, v69, v69
    v_dot2c_f32_bf16 v16, s58, v70
    v_dot2c_f32_bf16 v17, v70, v70
    v_dot2c_f32_bf16 v16, s58, v71
    v_dot2c_f32_bf16 v17, v71, v71
    v_dot2c_f32_bf16 v16, s58, v72
    v_dot2c_f32_bf16 v17, v72, v72
    v_dot2c_f32_bf16 v16, s58, v73
    v_dot2c_f32_bf16 v17, v73, v73
    v_dot2c_f32_bf16 v16, s58, v74
    v_dot2c_f32_bf16 v17, v74, v74
    v_dot2c_f32_bf16 v16, s58, v75
    v_dot2c_f32_bf16 v17, v75, v75
    v_dot2c_f32_bf16 v16, s58, v76
    v_dot2c_f32_bf16 v17, v76, v76
    v_dot2c_f32_bf16 v16, s58, v77
    v_dot2c_f32_bf16 v17, v77, v77
    v_dot2c_f32_bf16 v16, s58, v78
    v_dot2c_f32_bf16 v17, v78, v78
    v_dot2c_f32_bf16 v16, s58, v79
    v_dot2c_f32_bf16 v17, v79, v79
    v_dot2c_f32_bf16 v16, s58, v80
    v_dot2c_f32_bf16 v17, v80, v80
    v_dot2c_f32_bf16 v16, s58, v81
    v_dot2c_f32_bf16 v17, v81, v81
    v_dot2c_f32_bf16 v16, s58, v82
    v_dot2c_f32_bf16 v17, v82, v82
    v_dot2c_f32_bf16 v16, s58, v83
    v_dot2c_f32_bf16 v17, v83, v83
    v_dot2c_f32_bf16 v16, s58, v84
    v_dot2c_f32_bf16 v17, v84, v84
    v_dot2c_f32_bf16 v16, s58, v85
    v_dot2c_f32_bf16 v17, v85, v85
    v_dot2c_f32_bf16 v16, s58, v86
    v_dot2c_f32_bf16 v17, v86, v86
    v_dot2c_f32_bf16 v16, s58, v87
    v_dot2c_f32_bf16 v17, v87, v87
    s_waitcnt vmcnt(25)
    v_dot2c_f32_bf16 v18, s58, v88
    v_dot2c_f32_bf16 v19, v88, v88
    v_dot2c_f32_bf16 v18, s58, v89
    v_dot2c_f32_bf16 v19, v89, v89
    v_dot2c_f32_bf16 v18, s58, v90
    v_dot2c_f32_bf16 v19, v90, v90
    v_dot2c_f32_bf16 v18, s58, v91
    v_dot2c_f32_bf16 v19, v91, v91
    v_dot2c_f32_bf16 v18, s58, v92
    v_dot2c_f32_bf16 v19, v92, v92
    v_dot2c_f32_bf16 v18, s58, v93
    v_dot2c_f32_bf16 v19, v93, v93
    v_dot2c_f32_bf16 v18, s58, v94
    v_dot2c_f32_bf16 v19, v94, v94
    v_dot2c_f32_bf16 v18, s58, v95
    v_dot2c_f32_bf16 v19, v95, v95
    v_dot2c_f32_bf16 v18, s58, v96
    v_dot2c_f32_bf16 v19, v96, v96
    v_dot2c_f32_bf16 v18, s58, v97
    v_dot2c_f32_bf16 v19, v97, v97
    v_dot2c_f32_bf16 v18, s58, v98
    v_dot2c_f32_bf16 v19, v98, v98
    v_dot2c_f32_bf16 v18, s58, v99
    v_dot2c_f32_bf16 v19, v99, v99
    v_dot2c_f32_bf16 v18, s58, v100
    v_dot2c_f32_bf16 v19, v100, v100
    v_dot2c_f32_bf16 v18, s58, v101
    v_dot2c_f32_bf16 v19, v101, v101
    v_dot2c_f32_bf16 v18, s58, v102
    v_dot2c_f32_bf16 v19, v102, v102
    v_dot2c_f32_bf16 v18, s58, v103
    v_dot2c_f32_bf16 v19, v103, v103
    v_dot2c_f32_bf16 v18, s58, v104
    v_dot2c_f32_bf16 v19, v104, v104
    v_dot2c_f32_bf16 v18, s58, v105
    v_dot2c_f32_bf16 v19, v105, v105
    v_dot2c_f32_bf16 v18, s58, v106
    v_dot2c_f32_bf16 v19, v106, v106
    v_dot2c_f32_bf16 v18, s58, v107
    v_dot2c_f32_bf16 v19, v107, v107
    s_waitcnt vmcnt(20)
    v_dot2c_f32_bf16 v18, s58, v108
    v_dot2c_f32_bf16 v19, v108, v108
    v_dot2c_f32_bf16 v18, s58, v109
    v_dot2c_f32_bf16 v19, v109, v109
    v_dot2c_f32_bf16 v18, s58, v110
    v_dot2c_f32_bf16 v19, v110, v110
    v_dot2c_f32_bf16 v18, s58, v111
    v_dot2c_f32_bf16 v19, v111, v111
    v_dot2c_f32_bf16 v18, s58, v112
    v_dot2c_f32_bf16 v19, v112, v112
    v_dot2c_f32_bf16 v18, s58, v113
    v_dot2c_f32_bf16 v19, v113, v113
    v_dot2c_f32_bf16 v18, s58, v114
    v_dot2c_f32_bf16 v19, v114, v114
    v_dot2c_f32_bf16 v18, s58, v115
    v_dot2c_f32_bf16 v19, v115, v115
    v_dot2c_f32_bf16 v18, s58, v116
    v_dot2c_f32_bf16 v19, v116, v116
    v_dot2c_f32_bf16 v18, s58, v117
    v_dot2c_f32_bf16 v19, v117, v117
    v_dot2c_f32_bf16 v18, s58, v118
    v_dot2c_f32_bf16 v19, v118, v118
    v_dot2c_f32_bf16 v18, s58, v119
    v_dot2c_f32_bf16 v19, v119, v119
    v_dot2c_f32_bf16 v18, s58, v120
    v_dot2c_f32_bf16 v19, v120, v120
    v_dot2c_f32_bf16 v18, s58, v121
    v_dot2c_f32_bf16 v19, v121, v121
    v_dot2c_f32_bf16 v18, s58, v122
    v_dot2c_f32_bf16 v19, v122, v122
    v_dot2c_f32_bf16 v18, s58, v123
    v_dot2c_f32_bf16 v19, v123, v123
    v_dot2c_f32_bf16 v18, s58, v124
    v_dot2c_f32_bf16 v19, v124, v124
    v_dot2c_f32_bf16 v18, s58, v125
    v_dot2c_f32_bf16 v19, v125, v125
    v_dot2c_f32_bf16 v18, s58, v126
    v_dot2c_f32_bf16 v19, v126, v126
    v_dot2c_f32_bf16 v18, s58, v127
    v_dot2c_f32_bf16 v19, v127, v127
    s_waitcnt vmcnt(15)
    v_dot2c_f32_bf16 v20, s58, v128
    v_dot2c_f32_bf16 v21, v128, v128
    v_dot2c_f32_bf16 v20, s58, v129
    v_dot2c_f32_bf16 v21, v129, v129
    v_dot2c_f32_bf16 v20, s58, v130
    v_dot2c_f32_bf16 v21, v130, v130
    v_dot2c_f32_bf16 v20, s58, v131
    v_dot2c_f32_bf16 v21, v131, v131
    v_dot2c_f32_bf16 v20, s58, v132
    v_dot2c_f32_bf16 v21, v132, v132
    v_dot2c_f32_bf16 v20, s58, v133
    v_dot2c_f32_bf16 v21, v133, v133
    v_dot2c_f32_bf16 v20, s58, v134
    v_dot2c_f32_bf16 v21, v134, v134
    v_dot2c_f32_bf16 v20, s58, v135
    v_dot2c_f32_bf16 v21, v135, v135
    v_dot2c_f32_bf16 v20, s58, v136
    v_dot2c_f32_bf16 v21, v136, v136
    v_dot2c_f32_bf16 v20, s58, v137
    v_dot2c_f32_bf16 v21, v137, v137
    v_dot2c_f32_bf16 v20, s58, v138
    v_dot2c_f32_bf16 v21, v138, v138
    v_dot2c_f32_bf16 v20, s58, v139
    v_dot2c_f32_bf16 v21, v139, v139
    v_dot2c_f32_bf16 v20, s58, v140
    v_dot2c_f32_bf16 v21, v140, v140
    v_dot2c_f32_bf16 v20, s58, v141
    v_dot2c_f32_bf16 v21, v141, v141
    v_dot2c_f32_bf16 v20, s58, v142
    v_dot2c_f32_bf16 v21, v142, v142
    v_dot2c_f32_bf16 v20, s58, v143
    v_dot2c_f32_bf16 v21, v143, v143
    v_dot2c_f32_bf16 v20, s58, v144
    v_dot2c_f32_bf16 v21, v144, v144
    v_dot2c_f32_bf16 v20, s58, v145
    v_dot2c_f32_bf16 v21, v145, v145
    v_dot2c_f32_bf16 v20, s58, v146
    v_dot2c_f32_bf16 v21, v146, v146
    v_dot2c_f32_bf16 v20, s58, v147
    v_dot2c_f32_bf16 v21, v147, v147
    s_waitcnt vmcnt(10)
    v_dot2c_f32_bf16 v20, s58, v148
    v_dot2c_f32_bf16 v21, v148, v148
    v_dot2c_f32_bf16 v20, s58, v149
    v_dot2c_f32_bf16 v21, v149, v149
    v_dot2c_f32_bf16 v20, s58, v150
    v_dot2c_f32_bf16 v21, v150, v150
    v_dot2c_f32_bf16 v20, s58, v151
    v_dot2c_f32_bf16 v21, v151, v151
    v_dot2c_f32_bf16 v20, s58, v152
    v_dot2c_f32_bf16 v21, v152, v152
    v_dot2c_f32_bf16 v20, s58, v153
    v_dot2c_f32_bf16 v21, v153, v153
    v_dot2c_f32_bf16 v20, s58, v154
    v_dot2c_f32_bf16 v21, v154, v154
    v_dot2c_f32_bf16 v20, s58, v155
    v_dot2c_f32_bf16 v21, v155, v155
    v_dot2c_f32_bf16 v20, s58, v156
    v_dot2c_f32_bf16 v21, v156, v156
    v_dot2c_f32_bf16 v20, s58, v157
    v_dot2c_f32_bf16 v21, v157, v157
    v_dot2c_f32_bf16 v20, s58, v158
    v_dot2c_f32_bf16 v21, v158, v158
    v_dot2c_f32_bf16 v20, s58, v159
    v_dot2c_f32_bf16 v21, v159, v159
    v_dot2c_f32_bf16 v20, s58, v160
    v_dot2c_f32_bf16 v21, v160, v160
    v_dot2c_f32_bf16 v20, s58, v161
    v_dot2c_f32_bf16 v21, v161, v161
    v_dot2c_f32_bf16 v20, s58, v162
    v_dot2c_f32_bf16 v21, v162, v162
    v_dot2c_f32_bf16 v20, s58, v163
    v_dot2c_f32_bf16 v21, v163, v163
    v_dot2c_f32_bf16 v20, s58, v164
    v_dot2c_f32_bf16 v21, v164, v164
    v_dot2c_f32_bf16 v20, s58, v165
    v_dot2c_f32_bf16 v21, v165, v165
    v_dot2c_f32_bf16 v20, s58, v166
    v_dot2c_f32_bf16 v21, v166, v166
    v_dot2c_f32_bf16 v20, s58, v167
    v_dot2c_f32_bf16 v21, v167, v167
    s_waitcnt vmcnt(5)
    v_dot2c_f32_bf16 v22, s58, v168
    v_dot2c_f32_bf16 v23, v168, v168
    v_dot2c_f32_bf16 v22, s58, v169
    v_dot2c_f32_bf16 v23, v169, v169
    v_dot2c_f32_bf16 v22, s58, v170
    v_dot2c_f32_bf16 v23, v170, v170
    v_dot2c_f32_bf16 v22, s58, v171
    v_dot2c_f32_bf16 v23, v171, v171
    v_dot2c_f32_bf16 v22, s58, v172
    v_dot2c_f32_bf16 v23, v172, v172
    v_dot2c_f32_bf16 v22, s58, v173
    v_dot2c_f32_bf16 v23, v173, v173
    v_dot2c_f32_bf16 v22, s58, v174
    v_dot2c_f32_bf16 v23, v174, v174
    v_dot2c_f32_bf16 v22, s58, v175
    v_dot2c_f32_bf16 v23, v175, v175
    v_dot2c_f32_bf16 v22, s58, v176
    v_dot2c_f32_bf16 v23, v176, v176
    v_dot2c_f32_bf16 v22, s58, v177
    v_dot2c_f32_bf16 v23, v177, v177
    v_dot2c_f32_bf16 v22, s58, v178
    v_dot2c_f32_bf16 v23, v178, v178
    v_dot2c_f32_bf16 v22, s58, v179
    v_dot2c_f32_bf16 v23, v179, v179
    v_dot2c_f32_bf16 v22, s58, v180
    v_dot2c_f32_bf16 v23, v180, v180
    v_dot2c_f32_bf16 v22, s58, v181
    v_dot2c_f32_bf16 v23, v181, v181
    v_dot2c_f32_bf16 v22, s58, v182
    v_dot2c_f32_bf16 v23, v182, v182
    v_dot2c_f32_bf16 v22, s58, v183
    v_dot2c_f32_bf16 v23, v183, v183
    v_dot2c_f32_bf16 v22, s58, v184
    v_dot2c_f32_bf16 v23, v184, v184
    v_dot2c_f32_bf16 v22, s58, v185
    v_dot2c_f32_bf16 v23, v185, v185
    v_dot2c_f32_bf16 v22, s58, v186
    v_dot2c_f32_bf16 v23, v186, v186
    v_dot2c_f32_bf16 v22, s58, v187
    v_dot2c_f32_bf16 v23, v187, v187
    s_waitcnt vmcnt(0)
    v_dot2c_f32_bf16 v22, s58, v188
    v_dot2c_f32_bf16 v23, v188, v188
    v_dot2c_f32_bf16 v22, s58, v189
    v_dot2c_f32_bf16 v23, v189, v189
    v_dot2c_f32_bf16 v22, s58, v190
    v_dot2c_f32_bf16 v23, v190, v190
    v_dot2c_f32_bf16 v22, s58, v191
    v_dot2c_f32_bf16 v23, v191, v191
    v_dot2c_f32_bf16 v22, s58, v192
    v_dot2c_f32_bf16 v23, v192, v192
    v_dot2c_f32_bf16 v22, s58, v193
    v_dot2c_f32_bf16 v23, v193, v193
    v_dot2c_f32_bf16 v22, s58, v194
    v_dot2c_f32_bf16 v23, v194, v194
    v_dot2c_f32_bf16 v22, s58, v195
    v_dot2c_f32_bf16 v23, v195, v195
    v_dot2c_f32_bf16 v22, s58, v196
    v_dot2c_f32_bf16 v23, v196, v196
    v_dot2c_f32_bf16 v22, s58, v197
    v_dot2c_f32_bf16 v23, v197, v197
    v_dot2c_f32_bf16 v22, s58, v198
    v_dot2c_f32_bf16 v23, v198, v198
    v_dot2c_f32_bf16 v22, s58, v199
    v_dot2c_f32_bf16 v23, v199, v199
    v_dot2c_f32_bf16 v22, s58, v200
    v_dot2c_f32_bf16 v23, v200, v200
    v_dot2c_f32_bf16 v22, s58, v201
    v_dot2c_f32_bf16 v23, v201, v201
    v_dot2c_f32_bf16 v22, s58, v202
    v_dot2c_f32_bf16 v23, v202, v202
    v_dot2c_f32_bf16 v22, s58, v203
    v_dot2c_f32_bf16 v23, v203, v203
    v_dot2c_f32_bf16 v22, s58, v204
    v_dot2c_f32_bf16 v23, v204, v204
    v_dot2c_f32_bf16 v22, s58, v205
    v_dot2c_f32_bf16 v23, v205, v205
    v_dot2c_f32_bf16 v22, s58, v206
    v_dot2c_f32_bf16 v23, v206, v206
    v_dot2c_f32_bf16 v22, s58, v207
    v_dot2c_f32_bf16 v23, v207, v207
    s_nop 2
    ds_swizzle_b32 v24, v16 offset:1055
    ds_swizzle_b32 v25, v17 offset:1055
    ds_swizzle_b32 v26, v18 offset:1055
    ds_swizzle_b32 v27, v19 offset:1055
    ds_swizzle_b32 v28, v20 offset:1055
    ds_swizzle_b32 v29, v21 offset:1055
    ds_swizzle_b32 v30, v22 offset:1055
    ds_swizzle_b32 v31, v23 offset:1055
    s_waitcnt lgkmcnt(0)
    v_add_f32 v16, v16, v24
    v_add_f32 v17, v17, v25
    v_add_f32 v18, v18, v26
    v_add_f32 v19, v19, v27
    v_add_f32 v20, v20, v28
    v_add_f32 v21, v21, v29
    v_add_f32 v22, v22, v30
    v_add_f32 v23, v23, v31
    ds_swizzle_b32 v24, v16 offset:2079
    ds_swizzle_b32 v25, v17 offset:2079
    ds_swizzle_b32 v26, v18 offset:2079
    ds_swizzle_b32 v27, v19 offset:2079
    ds_swizzle_b32 v28, v20 offset:2079
    ds_swizzle_b32 v29, v21 offset:2079
    ds_swizzle_b32 v30, v22 offset:2079
    ds_swizzle_b32 v31, v23 offset:2079
    s_waitcnt lgkmcnt(0)
    v_add_f32 v16, v16, v24
    v_add_f32 v17, v17, v25
    v_add_f32 v18, v18, v26
    v_add_f32 v19, v19, v27
    v_add_f32 v20, v20, v28
    v_add_f32 v21, v21, v29
    v_add_f32 v22, v22, v30
    v_add_f32 v23, v23, v31
    ds_swizzle_b32 v24, v16 offset:4127
    ds_swizzle_b32 v25, v17 offset:4127
    ds_swizzle_b32 v26, v18 offset:4127
    ds_swizzle_b32 v27, v19 offset:4127
    ds_swizzle_b32 v28, v20 offset:4127
    ds_swizzle_b32 v29, v21 offset:4127
    ds_swizzle_b32 v30, v22 offset:4127
    ds_swizzle_b32 v31, v23 offset:4127
    s_waitcnt lgkmcnt(0)
    v_add_f32 v16, v16, v24
    v_add_f32 v17, v17, v25
    v_add_f32 v18, v18, v26
    v_add_f32 v19, v19, v27
    v_add_f32 v20, v20, v28
    v_add_f32 v21, v21, v29
    v_add_f32 v22, v22, v30
    v_add_f32 v23, v23, v31
    v_mul_f32 v16, 0x3acccccd, v16
    v_mul_f32 v17, 0x3acccccd, v17
    v_fma_f32 v17, -v16, v16, v17
    v_max_f32 v17, 0, v17
    v_cvt_pk_bf16_f32 v32, v16, v17
    v_lshlrev_b32 v24, 16, v32
    v_and_b32 v17, 0xffff0000, v32
    v_add_f32 v17, 0x3727c5ac, v17
    v_cvt_pk_bf16_f32 v32, v17, v17
    v_and_b32 v17, 0xffff0000, v32
    v_sqrt_f32 v17, v17
    s_nop 0
    v_cvt_pk_bf16_f32 v32, v17, v17
    v_and_b32 v17, 0xffff0000, v32
    v_rcp_f32 v28, v17
    v_mul_f32 v18, 0x3acccccd, v18
    v_mul_f32 v19, 0x3acccccd, v19
    v_fma_f32 v19, -v18, v18, v19
    v_max_f32 v19, 0, v19
    v_cvt_pk_bf16_f32 v32, v18, v19
    v_lshlrev_b32 v25, 16, v32
    v_and_b32 v19, 0xffff0000, v32
    v_add_f32 v19, 0x3727c5ac, v19
    v_cvt_pk_bf16_f32 v32, v19, v19
    v_and_b32 v19, 0xffff0000, v32
    v_sqrt_f32 v19, v19
    s_nop 0
    v_cvt_pk_bf16_f32 v32, v19, v19
    v_and_b32 v19, 0xffff0000, v32
    v_rcp_f32 v29, v19
    v_mul_f32 v20, 0x3acccccd, v20
    v_mul_f32 v21, 0x3acccccd, v21
    v_fma_f32 v21, -v20, v20, v21
    v_max_f32 v21, 0, v21
    v_cvt_pk_bf16_f32 v32, v20, v21
    v_lshlrev_b32 v26, 16, v32
    v_and_b32 v21, 0xffff0000, v32
    v_add_f32 v21, 0x3727c5ac, v21
    v_cvt_pk_bf16_f32 v32, v21, v21
    v_and_b32 v21, 0xffff0000, v32
    v_sqrt_f32 v21, v21
    s_nop 0
    v_cvt_pk_bf16_f32 v32, v21, v21
    v_and_b32 v21, 0xffff0000, v32
    v_rcp_f32 v30, v21
    v_mul_f32 v22, 0x3acccccd, v22
    v_mul_f32 v23, 0x3acccccd, v23
    v_fma_f32 v23, -v22, v22, v23
    v_max_f32 v23, 0, v23
    v_cvt_pk_bf16_f32 v32, v22, v23
    v_lshlrev_b32 v27, 16, v32
    v_and_b32 v23, 0xffff0000, v32
    v_add_f32 v23, 0x3727c5ac, v23
    v_cvt_pk_bf16_f32 v32, v23, v23
    v_and_b32 v23, 0xffff0000, v32
    v_sqrt_f32 v23, v23
    s_nop 0
    v_cvt_pk_bf16_f32 v32, v23, v23
    v_and_b32 v23, 0xffff0000, v32
    v_rcp_f32 v31, v23
    s_mov_b64 exec, s[34:35]
    buffer_store_dword v24, v2, s[16:19], s32 offen offset:0 sc1
    buffer_store_dword v28, v2, s[16:19], s33 offen offset:0 sc1
    buffer_store_dword v25, v2, s[16:19], s32 offen offset:32 sc1
    buffer_store_dword v29, v2, s[16:19], s33 offen offset:32 sc1
    buffer_store_dword v26, v2, s[16:19], s32 offen offset:64 sc1
    buffer_store_dword v30, v2, s[16:19], s33 offen offset:64 sc1
    buffer_store_dword v27, v2, s[16:19], s32 offen offset:96 sc1
    buffer_store_dword v31, v2, s[16:19], s33 offen offset:96 sc1
    s_mov_b64 exec, -1
LP_flag:
    s_waitcnt vmcnt(0)
    v_mov_b32 v12, 1
    v_mov_b32 v13, 160000
    s_mov_b64 exec, 1
    ds_add_rtn_u32 v14, v13, v12
    s_waitcnt lgkmcnt(0)
    v_readfirstlane_b32 s56, v14
    v_mov_b32 v13, s27
    v_lshlrev_b32 v13, 2, v13
    s_cmp_lg_u32 s56, 6
    s_cbranch_scc1 LP_done
    buffer_store_dword v12, v13, s[20:23], 0 offen sc1
LP_done:
    s_mov_b64 exec, -1
    s_endpgm
LP_tr:
    v_lshrrev_b32 v6, 3, v1
    v_mul_u32_u24 v6, 1280, v6
    v_and_b32 v7, 7, v1
    v_lshl_add_u32 v6, v7, 4, v6
    v_add_u32 v7, 9216, v6
    v_add_u32 v8, 18432, v6
    v_add_u32 v9, 27648, v6
    v_lshrrev_b32 v10, 5, v1
    v_lshlrev_b32 v10, 4, v10
    v_bfe_u32 v11, v1, 4, 1
    v_lshl_add_u32 v10, v11, 2, v10
    v_bfe_u32 v11, v1, 2, 2
    v_add_u32 v10, v10, v11
    v_lshlrev_b32 v10, 7, v10
    v_and_b32 v11, 3, v1
    v_lshl_add_u32 v10, v11, 3, v10
    v_lshlrev_b32 v11, 4, v1
    v_mov_b32 v13, 160000
LP_wt:
    s_sleep 8
    ds_read_b32 v14, v13
    s_waitcnt lgkmcnt(0)
    v_readfirstlane_b32 s56, v14
    s_nop 3
    s_cmp_lt_u32 s56, 6
    s_cbranch_scc1 LP_wt
    s_mov_b32 s56, s27
    s_mov_b32 s57, 0
    s_mov_b32 s62, s27
    s_mov_b32 s63, -10
LP_trl:
    s_min_u32 s60, s56, 679
    s_mul_i32 s58, s60, 52429
    s_lshr_b32 s58, s58, 19
    s_mul_i32 s59, s58, 10
    s_sub_u32 s59, s60, s59
    s_cmp_lt_u32 s58, 20
    s_cselect_b32 s12, s40, s48
    s_cselect_b32 s13, s41, s49
    s_mov_b32 s14, 1966080
    s_cselect_b32 s14, 819200, s14
    s_mov_b32 s15, 0x00020000
    s_cselect_b32 s60, 0, 20
    s_sub_u32 s60, s58, s60
    s_mul_i32 s60, s60, 40960
    s_lshl_b32 s61, s59, 7
    s_add_u32 s60, s60, s61
    s_mov_b32 m0, s57
    s_add_u32 s57, s57, 4096
    buffer_load_dwordx4 v6, s[12:15], s60 offen lds
    buffer_load_dwordx4 v7, s[12:15], s60 offen offset:1024 lds
    buffer_load_dwordx4 v8, s[12:15], s60 offen offset:2048 lds
    buffer_load_dwordx4 v9, s[12:15], s60 offen offset:3072 lds
    s_add_u32 s56, s56, 32
    s_add_i32 s63, s63, 1
    s_cmp_le_i32 s63, 0
    s_cbranch_scc1 LP_trl
    s_waitcnt vmcnt(40)
    ds_read_b64_tr_b16 v[64:65], v10 offset:0
    ds_read_b64_tr_b16 v[66:67], v10 offset:1024
    ds_read_b64_tr_b16 v[68:69], v10 offset:32
    ds_read_b64_tr_b16 v[70:71], v10 offset:1056
    ds_read_b64_tr_b16 v[72:73], v10 offset:64
    ds_read_b64_tr_b16 v[74:75], v10 offset:1088
    ds_read_b64_tr_b16 v[76:77], v10 offset:96
    ds_read_b64_tr_b16 v[78:79], v10 offset:1120
    v_add_u32 v10, 4096, v10
    s_mul_i32 s58, s62, 52429
    s_lshr_b32 s58, s58, 19
    s_mul_i32 s59, s58, 10
    s_sub_u32 s59, s62, s59
    s_mul_i32 s60, s58, 40960
    s_lshl_b32 s61, s59, 12
    s_add_u32 s60, s60, s61
    s_add_u32 s60, s60, 16777216
    s_waitcnt lgkmcnt(0)
    buffer_store_dwordx4 v[64:67], v11, s[16:19], s60 offen offset:0 sc1
    buffer_store_dwordx4 v[68:71], v11, s[16:19], s60 offen offset:1024 sc1
    buffer_store_dwordx4 v[72:75], v11, s[16:19], s60 offen offset:2048 sc1
    buffer_store_dwordx4 v[76:79], v11, s[16:19], s60 offen offset:3072 sc1
    s_add_u32 s62, s62, 32
    s_cmp_lt_u32 s62, 680
    s_cbranch_scc1 LP_trl
    s_endpgm
.globl k2_kernel
.p2align 8
.type k2_kernel,@function
k2_kernel:
    s_cmp_ge_u32 s2, 768
    s_cbranch_scc1 LK2_end
    s_load_dwordx2 s[4:5], s[0:1], 72
    s_load_dwordx2 s[6:7], s[0:1], 0
    v_and_b32 v1, 63, v0
    v_lshrrev_b32 v2, 6, v0
    s_and_b32 s3, s2, 255
    v_readfirstlane_b32 s20, v2
    s_lshr_b32 s16, s2, 8
    s_cmp_eq_u32 s16, 0
    s_cbranch_scc1 LK2_ffn
    s_sub_u32 s16, s16, 1
    s_setprio 1
LA:
    s_and_b32 s21, s3, 7
    s_lshl_b32 s21, s21, 2
    s_lshr_b32 s22, s3, 3
    s_and_b32 s23, s22, 3
    s_add_u32 s21, s21, s23
    s_lshr_b32 s22, s3, 5
    s_mul_i32 s25, s21, 81920
    s_lshl_b32 s26, s22, 3
    s_lshl_b32 s27, s16, 2
    s_add_u32 s26, s26, s27
    s_mul_i32 s27, s26, 1280
    s_add_u32 s27, s27, s25
    s_mul_i32 s28, s20, 20480
    s_add_u32 s28, s28, s25
    s_add_u32 s29, s28, 5242880
    s_add_u32 s28, s28, 2621440
    v_lshlrev_b32 v3, 4, v1
    v_and_b32 v4, 31, v1
    v_lshrrev_b32 v5, 5, v1
    v_lshlrev_b32 v6, 3, v4
    v_lshl_add_u32 v6, v5, 2, v6
    v_add_u32 v6, 1024, v6
    v_mul_u32_u24 v7, 320, v5
    v_lshl_add_u32 v7, v4, 4, v7
    s_mov_b32 s30, 0
    s_mov_b32 s12, 0x000FFFFF
    s_mov_b32 s13, 0x000FFFFF
    s_mov_b32 s14, 0xFFFFFFFF
    s_mov_b32 s15, 0
    s_add_u32 s36, s27, 2560
    s_mov_b32 s37, 0xbc000000
    s_waitcnt lgkmcnt(0)
    s_mov_b32 s8, s4
    s_mov_b32 s9, s5
    s_mov_b32 s10, 268435456
    s_mov_b32 s11, 0x00020000
    buffer_load_dwordx4 v[8:11], v3, s[8:11], s27 offen offset:0
    buffer_load_dword v12, v6, s[8:11], s27 offen offset:0
    buffer_load_dwordx4 v[16:19], v3, s[8:11], s27 offen offset:1280
    buffer_load_dword v20, v6, s[8:11], s27 offen offset:1280
    buffer_load_dwordx4 v[24:27], v3, s[8:11], s36 offen offset:0
    buffer_load_dword v28, v6, s[8:11], s36 offen offset:0
    buffer_load_dwordx4 v[32:35], v3, s[8:11], s36 offen offset:1280
    buffer_load_dword v36, v6, s[8:11], s36 offen offset:1280
    s_branch LA_pro
LA_restart:
    v_mov_b32 v13, 0
    v_mov_b32 v14, 0
    v_mov_b32 v40, 0xff800000
    v_mov_b32 v21, 0
    v_mov_b32 v22, 0
    v_mov_b32 v41, 0xff800000
    v_mov_b32 v29, 0
    v_mov_b32 v30, 0
    v_mov_b32 v42, 0xff800000
    v_mov_b32 v37, 0
    v_mov_b32 v38, 0
    v_mov_b32 v43, 0xff800000
    s_mov_b32 s31, s28
    s_mov_b32 s32, 16
LA_maxloop:
    buffer_load_dwordx4 v[136:139], v3, s[8:11], s31 offen offset:0
    buffer_load_dword v140, v6, s[8:11], s31 offen offset:0
    s_waitcnt vmcnt(0)
    v_mfma_f32_32x32x16_bf16 v[72:87], v[136:139], v[8:11], 0
    v_mfma_f32_32x32x16_bf16 v[72:87], v[140:143], v[12:15], v[72:87]
    v_mfma_f32_32x32x16_bf16 v[88:103], v[136:139], v[16:19], 0
    v_mfma_f32_32x32x16_bf16 v[88:103], v[140:143], v[20:23], v[88:103]
    v_mfma_f32_32x32x16_bf16 v[104:119], v[136:139], v[24:27], 0
    v_mfma_f32_32x32x16_bf16 v[104:119], v[140:143], v[28:31], v[104:119]
    v_mfma_f32_32x32x16_bf16 v[120:135], v[136:139], v[32:35], 0
    v_mfma_f32_32x32x16_bf16 v[120:135], v[140:143], v[36:39], v[120:135]
    s_nop 15
    s_nop 3
    v_max3_f32 v40, v40, v72, v73
    v_max3_f32 v40, v40, v74, v75
    v_max3_f32 v40, v40, v76, v77
    v_max3_f32 v40, v40, v78, v79
    v_max3_f32 v40, v40, v80, v81
    v_max3_f32 v40, v40, v82, v83
    v_max3_f32 v40, v40, v84, v85
    v_max3_f32 v40, v40, v86, v87
    v_max3_f32 v41, v41, v88, v89
    v_max3_f32 v41, v41, v90, v91
    v_max3_f32 v41, v41, v92, v93
    v_max3_f32 v41, v41, v94, v95
    v_max3_f32 v41, v41, v96, v97
    v_max3_f32 v41, v41, v98, v99
    v_max3_f32 v41, v41, v100, v101
    v_max3_f32 v41, v41, v102, v103
    v_max3_f32 v42, v42, v104, v105
    v_max3_f32 v42, v42, v106, v107
    v_max3_f32 v42, v42, v108, v109
    v_max3_f32 v42, v42, v110, v111
    v_max3_f32 v42, v42, v112, v113
    v_max3_f32 v42, v42, v114, v115
    v_max3_f32 v42, v42, v116, v117
    v_max3_f32 v42, v42, v118, v119
    v_max3_f32 v43, v43, v120, v121
    v_max3_f32 v43, v43, v122, v123
    v_max3_f32 v43, v43, v124, v125
    v_max3_f32 v43, v43, v126, v127
    v_max3_f32 v43, v43, v128, v129
    v_max3_f32 v43, v43, v130, v131
    v_max3_f32 v43, v43, v132, v133
    v_max3_f32 v43, v43, v134, v135
    s_add_u32 s31, s31, 1280
    s_sub_u32 s32, s32, 1
    s_cmp_lg_u32 s32, 0
    s_cbranch_scc1 LA_maxloop
LA_pro:
    buffer_load_dwordx4 v[136:139], v3, s[8:11], s28 offen offset:0
    buffer_load_dword v140, v6, s[8:11], s28 offen offset:0
    v_mov_b32 v44, 0x3f803f80
    v_cmp_eq_u32 vcc, 20, v4
    v_cndmask_b32 v46, 0, v44, s[14:15]
    s_nop 0
    v_cndmask_b32 v45, 0, v44, vcc
    v_mov_b32 v152, v45
    v_mov_b32 v153, v45
    v_mov_b32 v154, v45
    v_mov_b32 v155, v45
    v_mov_b32 v156, v45
    v_mov_b32 v157, v45
    v_mov_b32 v158, v45
    v_mov_b32 v159, v45
    s_mov_b64 exec, s[12:13]
    buffer_load_dwordx4 v[152:155], v7, s[8:11], s29 offen offset:0
    buffer_load_dwordx4 v[156:159], v7, s[8:11], s29 offen offset:640
    s_mov_b64 exec, -1
    buffer_load_dwordx4 v[144:147], v3, s[8:11], s28 offen offset:1280
    buffer_load_dword v148, v6, s[8:11], s28 offen offset:1280
    v_mov_b32 v160, v45
    v_mov_b32 v161, v45
    v_mov_b32 v162, v45
    v_mov_b32 v163, v45
    v_mov_b32 v164, v45
    v_mov_b32 v165, v45
    v_mov_b32 v166, v45
    v_mov_b32 v167, v45
    v_mov_b32 v141, v46
    v_mov_b32 v142, v46
    v_mov_b32 v143, 0
    v_mov_b32 v149, v46
    v_mov_b32 v150, v46
    v_mov_b32 v151, 0
    v_mov_b32 v56, 0
    v_mov_b32 v57, 0
    v_mov_b32 v58, 0
    v_mov_b32 v59, 0
    v_mov_b32 v60, 0
    v_mov_b32 v61, 0
    v_mov_b32 v62, 0
    v_mov_b32 v63, 0
    v_lshlrev_b32 v0, 2, v1
    s_lshl_b32 s34, s20, 10
    s_add_u32 s34, s34, 49152
    v_add_u32 v0, s34, v0
    s_cmp_lg_u32 s30, 0
    s_cbranch_scc1 LA_setm0
    v_mov_b32 v13, 0
    v_mov_b32 v14, 0
    v_mov_b32 v15, 0
    v_mov_b32 v21, 0
    v_mov_b32 v22, 0
    v_mov_b32 v23, 0
    v_mov_b32 v29, 0
    v_mov_b32 v30, 0
    v_mov_b32 v31, 0
    v_mov_b32 v37, 0
    v_mov_b32 v38, 0
    v_mov_b32 v39, 0
    s_waitcnt vmcnt(4)
    v_mfma_f32_32x32x16_bf16 v[72:87], v[136:139], v[8:11], 0
    v_mfma_f32_32x32x16_bf16 v[72:87], v[140:143], v[12:15], v[72:87]
    v_mfma_f32_32x32x16_bf16 v[88:103], v[136:139], v[16:19], 0
    v_mfma_f32_32x32x16_bf16 v[88:103], v[140:143], v[20:23], v[88:103]
    v_mfma_f32_32x32x16_bf16 v[104:119], v[136:139], v[24:27], 0
    v_mfma_f32_32x32x16_bf16 v[104:119], v[140:143], v[28:31], v[104:119]
    v_mfma_f32_32x32x16_bf16 v[120:135], v[136:139], v[32:35], 0
    v_mfma_f32_32x32x16_bf16 v[120:135], v[140:143], v[36:39], v[120:135]
    s_nop 5
    v_max3_f32 v40, v72, v73, v74
    v_max_f32 v40, v40, v75
    v_max3_f32 v40, v40, v76, v77
    v_max3_f32 v40, v40, v78, v79
    v_max3_f32 v40, v40, v80, v81
    v_max3_f32 v40, v40, v82, v83
    v_max3_f32 v40, v40, v84, v85
    v_max3_f32 v40, v40, v86, v87
    v_max3_f32 v41, v88, v89, v90
    v_max_f32 v41, v41, v91
    v_max3_f32 v41, v41, v92, v93
    v_max3_f32 v41, v41, v94, v95
    v_max3_f32 v41, v41, v96, v97
    v_max3_f32 v41, v41, v98, v99
    v_max3_f32 v41, v41, v100, v101
    v_max3_f32 v41, v41, v102, v103
    v_max3_f32 v42, v104, v105, v106
    v_max_f32 v42, v42, v107
    v_max3_f32 v42, v42, v108, v109
    v_max3_f32 v42, v42, v110, v111
    v_max3_f32 v42, v42, v112, v113
    v_max3_f32 v42, v42, v114, v115
    v_max3_f32 v42, v42, v116, v117
    v_max3_f32 v42, v42, v118, v119
    v_max3_f32 v43, v120, v121, v122
    v_max_f32 v43, v43, v123
    v_max3_f32 v43, v43, v124, v125
    v_max3_f32 v43, v43, v126, v127
    v_max3_f32 v43, v43, v128, v129
    v_max3_f32 v43, v43, v130, v131
    v_max3_f32 v43, v43, v132, v133
    v_max3_f32 v43, v43, v134, v135
    v_fma_f32 v40, abs(v40), s37, v40
    v_and_b32 v40, 0xffff0000, v40
    ds_write_b32 v0, v40 offset:0
    v_xor_b32 v44, 0x80000000, v40
    v_cndmask_b32 v13, 0, v44, s[14:15]
    v_fma_f32 v41, abs(v41), s37, v41
    v_and_b32 v41, 0xffff0000, v41
    ds_write_b32 v0, v41 offset:256
    v_xor_b32 v45, 0x80000000, v41
    v_cndmask_b32 v21, 0, v45, s[14:15]
    v_fma_f32 v42, abs(v42), s37, v42
    v_and_b32 v42, 0xffff0000, v42
    ds_write_b32 v0, v42 offset:512
    v_xor_b32 v46, 0x80000000, v42
    v_cndmask_b32 v29, 0, v46, s[14:15]
    v_fma_f32 v43, abs(v43), s37, v43
    v_and_b32 v43, 0xffff0000, v43
    ds_write_b32 v0, v43 offset:768
    v_xor_b32 v47, 0x80000000, v43
    v_cndmask_b32 v37, 0, v47, s[14:15]
    s_branch LA_go
LA_setm0:
    s_waitcnt vmcnt(4)
    v_mov_b32 v44, v40
    v_mov_b32 v45, v40
    s_nop 1
    v_permlane32_swap_b32 v44, v45
    s_nop 1
    v_max_f32 v40, v44, v45
    v_sub_f32 v44, 0, v40
    ds_write_b32 v0, v40 offset:0
    v_and_b32 v45, 0xffff0000, v44
    v_sub_f32 v44, v44, v45
    v_and_b32 v46, 0xffff0000, v44
    v_sub_f32 v44, v44, v46
    v_lshrrev_b32 v45, 16, v45
    v_or_b32 v45, v45, v46
    v_lshrrev_b32 v44, 16, v44
    v_cndmask_b32 v13, 0, v45, s[14:15]
    v_cndmask_b32 v14, 0, v44, s[14:15]
    v_mov_b32 v44, v41
    v_mov_b32 v45, v41
    s_nop 1
    v_permlane32_swap_b32 v44, v45
    s_nop 1
    v_max_f32 v41, v44, v45
    v_sub_f32 v44, 0, v41
    ds_write_b32 v0, v41 offset:256
    v_and_b32 v45, 0xffff0000, v44
    v_sub_f32 v44, v44, v45
    v_and_b32 v46, 0xffff0000, v44
    v_sub_f32 v44, v44, v46
    v_lshrrev_b32 v45, 16, v45
    v_or_b32 v45, v45, v46
    v_lshrrev_b32 v44, 16, v44
    v_cndmask_b32 v21, 0, v45, s[14:15]
    v_cndmask_b32 v22, 0, v44, s[14:15]
    v_mov_b32 v44, v42
    v_mov_b32 v45, v42
    s_nop 1
    v_permlane32_swap_b32 v44, v45
    s_nop 1
    v_max_f32 v42, v44, v45
    v_sub_f32 v44, 0, v42
    ds_write_b32 v0, v42 offset:512
    v_and_b32 v45, 0xffff0000, v44
    v_sub_f32 v44, v44, v45
    v_and_b32 v46, 0xffff0000, v44
    v_sub_f32 v44, v44, v46
    v_lshrrev_b32 v45, 16, v45
    v_or_b32 v45, v45, v46
    v_lshrrev_b32 v44, 16, v44
    v_cndmask_b32 v29, 0, v45, s[14:15]
    v_cndmask_b32 v30, 0, v44, s[14:15]
    v_mov_b32 v44, v43
    v_mov_b32 v45, v43
    s_nop 1
    v_permlane32_swap_b32 v44, v45
    s_nop 1
    v_max_f32 v43, v44, v45
    v_sub_f32 v44, 0, v43
    ds_write_b32 v0, v43 offset:768
    v_and_b32 v45, 0xffff0000, v44
    v_sub_f32 v44, v44, v45
    v_and_b32 v46, 0xffff0000, v44
    v_sub_f32 v44, v44, v46
    v_lshrrev_b32 v45, 16, v45
    v_or_b32 v45, v45, v46
    v_lshrrev_b32 v44, 16, v44
    v_cndmask_b32 v37, 0, v45, s[14:15]
    v_cndmask_b32 v38, 0, v44, s[14:15]
LA_go:
    s_waitcnt lgkmcnt(0)
    v_mfma_f32_32x32x16_bf16 v[40:55], v[136:139], v[8:11], 0
    v_mfma_f32_32x32x16_bf16 v[40:55], v[140:143], v[12:15], v[40:55]
    v_mfma_f32_32x32x16_bf16 v[72:87], v[56:59], v[56:59], 0
    v_mfma_f32_32x32x16_bf16 v[88:103], v[56:59], v[56:59], 0
    v_mfma_f32_32x32x16_bf16 v[104:119], v[56:59], v[56:59], 0
    v_mfma_f32_32x32x16_bf16 v[120:135], v[56:59], v[56:59], 0
    s_nop 4
    s_add_u32 s31, s28, 2560
    s_add_u32 s33, s29, 1280
    s_mov_b32 s32, 8
.p2align 6
LA_loop:
    v_mfma_f32_32x32x16_bf16 v[120:135], v[160:163], v[56:59], v[120:135]
    v_exp_f32 v40, v40
    v_exp_f32 v41, v41
    v_exp_f32 v42, v42
    v_mfma_f32_32x32x16_bf16 v[120:135], v[164:167], v[60:63], v[120:135]
    s_mov_b64 exec, s[12:13]
    buffer_load_dwordx4 v[160:163], v7, s[8:11], s33 offen offset:0
    buffer_load_dwordx4 v[164:167], v7, s[8:11], s33 offen offset:640
    s_mov_b64 exec, -1
    s_add_u32 s33, s33, 1280
    v_exp_f32 v43, v43
    v_cvt_pk_bf16_f32 v40, v40, v41
    v_exp_f32 v44, v44
    v_exp_f32 v45, v45
    v_mfma_f32_32x32x16_bf16 v[56:71], v[136:139], v[16:19], 0
    v_cvt_pk_bf16_f32 v41, v42, v43
    v_exp_f32 v46, v46
    v_exp_f32 v47, v47
    v_exp_f32 v48, v48
    v_mfma_f32_32x32x16_bf16 v[56:71], v[140:143], v[20:23], v[56:71]
    v_cvt_pk_bf16_f32 v42, v44, v45
    v_cvt_pk_bf16_f32 v43, v46, v47
    v_exp_f32 v49, v49
    v_exp_f32 v50, v50
    v_exp_f32 v51, v51
    v_cvt_pk_bf16_f32 v44, v48, v49
    v_exp_f32 v52, v52
    v_exp_f32 v53, v53
    v_cvt_pk_bf16_f32 v45, v50, v51
    v_exp_f32 v54, v54
    v_exp_f32 v55, v55
    v_cvt_pk_bf16_f32 v46, v52, v53
    v_cvt_pk_bf16_f32 v47, v54, v55
    s_waitcnt vmcnt(4)
    v_mfma_f32_32x32x16_bf16 v[72:87], v[152:155], v[40:43], v[72:87]
    v_exp_f32 v56, v56
    v_exp_f32 v57, v57
    v_exp_f32 v58, v58
    v_mfma_f32_32x32x16_bf16 v[72:87], v[156:159], v[44:47], v[72:87]
    v_exp_f32 v59, v59
    v_cvt_pk_bf16_f32 v56, v56, v57
    v_exp_f32 v60, v60
    v_exp_f32 v61, v61
    v_mfma_f32_32x32x16_bf16 v[40:55], v[136:139], v[24:27], 0
    v_cvt_pk_bf16_f32 v57, v58, v59
    v_exp_f32 v62, v62
    v_exp_f32 v63, v63
    v_exp_f32 v64, v64
    v_mfma_f32_32x32x16_bf16 v[40:55], v[140:143], v[28:31], v[40:55]
    v_cvt_pk_bf16_f32 v58, v60, v61
    v_cvt_pk_bf16_f32 v59, v62, v63
    v_exp_f32 v65, v65
    v_exp_f32 v66, v66
    v_exp_f32 v67, v67
    v_cvt_pk_bf16_f32 v60, v64, v65
    v_exp_f32 v68, v68
    v_exp_f32 v69, v69
    v_cvt_pk_bf16_f32 v61, v66, v67
    v_exp_f32 v70, v70
    v_exp_f32 v71, v71
    v_cvt_pk_bf16_f32 v62, v68, v69
    v_cvt_pk_bf16_f32 v63, v70, v71
    v_mfma_f32_32x32x16_bf16 v[88:103], v[152:155], v[56:59], v[88:103]
    v_exp_f32 v40, v40
    v_exp_f32 v41, v41
    v_exp_f32 v42, v42
    v_mfma_f32_32x32x16_bf16 v[88:103], v[156:159], v[60:63], v[88:103]
    v_exp_f32 v43, v43
    v_cvt_pk_bf16_f32 v40, v40, v41
    v_exp_f32 v44, v44
    v_exp_f32 v45, v45
    v_mfma_f32_32x32x16_bf16 v[56:71], v[136:139], v[32:35], 0
    v_cvt_pk_bf16_f32 v41, v42, v43
    v_exp_f32 v46, v46
    v_exp_f32 v47, v47
    v_exp_f32 v48, v48
    v_mfma_f32_32x32x16_bf16 v[56:71], v[140:143], v[36:39], v[56:71]
    buffer_load_dwordx4 v[136:139], v3, s[8:11], s31 offen offset:0
    buffer_load_dword v140, v6, s[8:11], s31 offen offset:0
    s_add_u32 s31, s31, 1280
    v_cvt_pk_bf16_f32 v42, v44, v45
    v_cvt_pk_bf16_f32 v43, v46, v47
    v_exp_f32 v49, v49
    v_exp_f32 v50, v50
    v_exp_f32 v51, v51
    v_cvt_pk_bf16_f32 v44, v48, v49
    v_exp_f32 v52, v52
    v_exp_f32 v53, v53
    v_cvt_pk_bf16_f32 v45, v50, v51
    v_exp_f32 v54, v54
    v_exp_f32 v55, v55
    v_cvt_pk_bf16_f32 v46, v52, v53
    v_cvt_pk_bf16_f32 v47, v54, v55
    s_waitcnt vmcnt(4)
    v_mfma_f32_32x32x16_bf16 v[104:119], v[152:155], v[40:43], v[104:119]
    v_exp_f32 v56, v56
    v_exp_f32 v57, v57
    v_exp_f32 v58, v58
    v_mfma_f32_32x32x16_bf16 v[104:119], v[156:159], v[44:47], v[104:119]
    v_exp_f32 v59, v59
    v_cvt_pk_bf16_f32 v56, v56, v57
    v_exp_f32 v60, v60
    v_exp_f32 v61, v61
    v_mfma_f32_32x32x16_bf16 v[40:55], v[144:147], v[8:11], 0
    v_cvt_pk_bf16_f32 v57, v58, v59
    v_exp_f32 v62, v62
    v_exp_f32 v63, v63
    v_exp_f32 v64, v64
    v_mfma_f32_32x32x16_bf16 v[40:55], v[148:151], v[12:15], v[40:55]
    v_cvt_pk_bf16_f32 v58, v60, v61
    v_cvt_pk_bf16_f32 v59, v62, v63
    v_exp_f32 v65, v65
    v_exp_f32 v66, v66
    v_exp_f32 v67, v67
    v_cvt_pk_bf16_f32 v60, v64, v65
    v_exp_f32 v68, v68
    v_exp_f32 v69, v69
    v_cvt_pk_bf16_f32 v61, v66, v67
    v_exp_f32 v70, v70
    v_exp_f32 v71, v71
    v_cvt_pk_bf16_f32 v62, v68, v69
    v_cvt_pk_bf16_f32 v63, v70, v71
    v_mfma_f32_32x32x16_bf16 v[120:135], v[152:155], v[56:59], v[120:135]
    v_exp_f32 v40, v40
    v_exp_f32 v41, v41
    v_exp_f32 v42, v42
    v_mfma_f32_32x32x16_bf16 v[120:135], v[156:159], v[60:63], v[120:135]
    s_mov_b64 exec, s[12:13]
    buffer_load_dwordx4 v[152:155], v7, s[8:11], s33 offen offset:0
    buffer_load_dwordx4 v[156:159], v7, s[8:11], s33 offen offset:640
    s_mov_b64 exec, -1
    s_add_u32 s33, s33, 1280
    v_exp_f32 v43, v43
    v_cvt_pk_bf16_f32 v40, v40, v41
    v_exp_f32 v44, v44
    v_exp_f32 v45, v45
    v_mfma_f32_32x32x16_bf16 v[56:71], v[144:147], v[16:19], 0
    v_cvt_pk_bf16_f32 v41, v42, v43
    v_exp_f32 v46, v46
    v_exp_f32 v47, v47
    v_exp_f32 v48, v48
    v_mfma_f32_32x32x16_bf16 v[56:71], v[148:151], v[20:23], v[56:71]
    v_cvt_pk_bf16_f32 v42, v44, v45
    v_cvt_pk_bf16_f32 v43, v46, v47
    v_exp_f32 v49, v49
    v_exp_f32 v50, v50
    v_exp_f32 v51, v51
    v_cvt_pk_bf16_f32 v44, v48, v49
    v_exp_f32 v52, v52
    v_exp_f32 v53, v53
    v_cvt_pk_bf16_f32 v45, v50, v51
    v_exp_f32 v54, v54
    v_exp_f32 v55, v55
    v_cvt_pk_bf16_f32 v46, v52, v53
    v_cvt_pk_bf16_f32 v47, v54, v55
    s_waitcnt vmcnt(4)
    v_mfma_f32_32x32x16_bf16 v[72:87], v[160:163], v[40:43], v[72:87]
    v_exp_f32 v56, v56
    v_exp_f32 v57, v57
    v_exp_f32 v58, v58
    v_mfma_f32_32x32x16_bf16 v[72:87], v[164:167], v[44:47], v[72:87]
    v_exp_f32 v59, v59
    v_cvt_pk_bf16_f32 v56, v56, v57
    v_exp_f32 v60, v60
    v_exp_f32 v61, v61
    v_mfma_f32_32x32x16_bf16 v[40:55], v[144:147], v[24:27], 0
    v_cvt_pk_bf16_f32 v57, v58, v59
    v_exp_f32 v62, v62
    v_exp_f32 v63, v63
    v_exp_f32 v64, v64
    v_mfma_f32_32x32x16_bf16 v[40:55], v[148:151], v[28:31], v[40:55]
    v_cvt_pk_bf16_f32 v58, v60, v61
    v_cvt_pk_bf16_f32 v59, v62, v63
    v_exp_f32 v65, v65
    v_exp_f32 v66, v66
    v_exp_f32 v67, v67
    v_cvt_pk_bf16_f32 v60, v64, v65
    v_exp_f32 v68, v68
    v_exp_f32 v69, v69
    v_cvt_pk_bf16_f32 v61, v66, v67
    v_exp_f32 v70, v70
    v_exp_f32 v71, v71
    v_cvt_pk_bf16_f32 v62, v68, v69
    v_cvt_pk_bf16_f32 v63, v70, v71
    v_mfma_f32_32x32x16_bf16 v[88:103], v[160:163], v[56:59], v[88:103]
    v_exp_f32 v40, v40
    v_exp_f32 v41, v41
    v_exp_f32 v42, v42
    v_mfma_f32_32x32x16_bf16 v[88:103], v[164:167], v[60:63], v[88:103]
    v_exp_f32 v43, v43
    v_cvt_pk_bf16_f32 v40, v40, v41
    v_exp_f32 v44, v44
    v_exp_f32 v45, v45
    v_mfma_f32_32x32x16_bf16 v[56:71], v[144:147], v[32:35], 0
    v_cvt_pk_bf16_f32 v41, v42, v43
    v_exp_f32 v46, v46
    v_exp_f32 v47, v47
    v_exp_f32 v48, v48
    v_mfma_f32_32x32x16_bf16 v[56:71], v[148:151], v[36:39], v[56:71]
    buffer_load_dwordx4 v[144:147], v3, s[8:11], s31 offen offset:0
    buffer_load_dword v148, v6, s[8:11], s31 offen offset:0
    s_add_u32 s31, s31, 1280
    v_cvt_pk_bf16_f32 v42, v44, v45
    v_cvt_pk_bf16_f32 v43, v46, v47
    v_exp_f32 v49, v49
    v_exp_f32 v50, v50
    v_exp_f32 v51, v51
    v_cvt_pk_bf16_f32 v44, v48, v49
    v_exp_f32 v52, v52
    v_exp_f32 v53, v53
    v_cvt_pk_bf16_f32 v45, v50, v51
    v_exp_f32 v54, v54
    v_exp_f32 v55, v55
    v_cvt_pk_bf16_f32 v46, v52, v53
    v_cvt_pk_bf16_f32 v47, v54, v55
    s_waitcnt vmcnt(4)
    v_mfma_f32_32x32x16_bf16 v[104:119], v[160:163], v[40:43], v[104:119]
    v_exp_f32 v56, v56
    v_exp_f32 v57, v57
    v_exp_f32 v58, v58
    v_mfma_f32_32x32x16_bf16 v[104:119], v[164:167], v[44:47], v[104:119]
    v_exp_f32 v59, v59
    v_cvt_pk_bf16_f32 v56, v56, v57
    v_exp_f32 v60, v60
    v_exp_f32 v61, v61
    v_mfma_f32_32x32x16_bf16 v[40:55], v[136:139], v[8:11], 0
    v_cvt_pk_bf16_f32 v57, v58, v59
    v_exp_f32 v62, v62
    v_exp_f32 v63, v63
    v_exp_f32 v64, v64
    v_mfma_f32_32x32x16_bf16 v[40:55], v[140:143], v[12:15], v[40:55]
    v_cvt_pk_bf16_f32 v58, v60, v61
    v_cvt_pk_bf16_f32 v59, v62, v63
    v_exp_f32 v65, v65
    v_exp_f32 v66, v66
    v_exp_f32 v67, v67
    v_cvt_pk_bf16_f32 v60, v64, v65
    v_exp_f32 v68, v68
    v_exp_f32 v69, v69
    v_cvt_pk_bf16_f32 v61, v66, v67
    v_exp_f32 v70, v70
    v_exp_f32 v71, v71
    v_cvt_pk_bf16_f32 v62, v68, v69
    v_cvt_pk_bf16_f32 v63, v70, v71
    s_sub_u32 s32, s32, 1
    s_cmp_lg_u32 s32, 0
    s_cbranch_scc1 LA_loop
    v_mfma_f32_32x32x16_bf16 v[120:135], v[160:163], v[56:59], v[120:135]
    v_mfma_f32_32x32x16_bf16 v[120:135], v[164:167], v[60:63], v[120:135]
    s_mul_i32 s34, s20, 3072
    v_add_u32 v64, s34, v3
    v_mov_b32 v65, 0x71800000
    ds_write_b128 v64, v[72:75] offset:0
    ds_write_b128 v64, v[76:79] offset:1024
    ds_write_b128 v64, v[80:83] offset:2048
    v_and_b32 v66, 0x7fffffff, v72
    v_and_b32 v67, 0x7fffffff, v73
    v_add_f32 v66, v66, abs(v74)
    v_add_f32 v67, v67, abs(v75)
    v_add_f32 v66, v66, abs(v76)
    v_add_f32 v67, v67, abs(v77)
    v_add_f32 v66, v66, abs(v78)
    v_add_f32 v67, v67, abs(v79)
    v_add_f32 v66, v66, abs(v80)
    v_add_f32 v67, v67, abs(v81)
    v_add_f32 v66, v66, abs(v82)
    v_add_f32 v67, v67, abs(v83)
    ds_write_b128 v64, v[88:91] offset:12288
    ds_write_b128 v64, v[92:95] offset:13312
    ds_write_b128 v64, v[96:99] offset:14336
    v_add_f32 v66, v66, abs(v88)
    v_add_f32 v67, v67, abs(v89)
    v_add_f32 v66, v66, abs(v90)
    v_add_f32 v67, v67, abs(v91)
    v_add_f32 v66, v66, abs(v92)
    v_add_f32 v67, v67, abs(v93)
    v_add_f32 v66, v66, abs(v94)
    v_add_f32 v67, v67, abs(v95)
    v_add_f32 v66, v66, abs(v96)
    v_add_f32 v67, v67, abs(v97)
    v_add_f32 v66, v66, abs(v98)
    v_add_f32 v67, v67, abs(v99)
    ds_write_b128 v64, v[104:107] offset:24576
    ds_write_b128 v64, v[108:111] offset:25600
    ds_write_b128 v64, v[112:115] offset:26624
    v_add_f32 v66, v66, abs(v104)
    v_add_f32 v67, v67, abs(v105)
    v_add_f32 v66, v66, abs(v106)
    v_add_f32 v67, v67, abs(v107)
    v_add_f32 v66, v66, abs(v108)
    v_add_f32 v67, v67, abs(v109)
    v_add_f32 v66, v66, abs(v110)
    v_add_f32 v67, v67, abs(v111)
    v_add_f32 v66, v66, abs(v112)
    v_add_f32 v67, v67, abs(v113)
    v_add_f32 v66, v66, abs(v114)
    v_add_f32 v67, v67, abs(v115)
    ds_write_b128 v64, v[120:123] offset:36864
    ds_write_b128 v64, v[124:127] offset:37888
    ds_write_b128 v64, v[128:131] offset:38912
    v_add_f32 v66, v66, abs(v120)
    v_add_f32 v67, v67, abs(v121)
    v_add_f32 v66, v66, abs(v122)
    v_add_f32 v67, v67, abs(v123)
    v_add_f32 v66, v66, abs(v124)
    v_add_f32 v67, v67, abs(v125)
    v_add_f32 v66, v66, abs(v126)
    v_add_f32 v67, v67, abs(v127)
    v_add_f32 v66, v66, abs(v128)
    v_add_f32 v67, v67, abs(v129)
    v_add_f32 v66, v66, abs(v130)
    v_add_f32 v67, v67, abs(v131)
    v_add_f32 v66, v66, v67
    v_cmp_nlt_f32 vcc, v66, v65
    s_cmp_lg_u32 s30, 0
    s_cbranch_scc1 LA_comb
    s_nop 2
    s_cmp_eq_u64 vcc, 0
    s_cbranch_scc1 LA_comb
    s_mov_b32 s30, 1
    s_waitcnt vmcnt(0) lgkmcnt(0)
    s_branch LA_restart
LA_comb:
    s_mul_i32 s34, s20, 12288
    v_add_u32 v64, s34, v3
    v_lshlrev_b32 v65, 2, v4
    s_lshl_b32 s34, s20, 8
    s_add_u32 s34, s34, 49152
    v_add_u32 v65, s34, v65
    s_add_u32 s26, s26, s20
    s_waitcnt lgkmcnt(0)
    s_barrier
    ds_read_b32 v8, v65 offset:0
    ds_read_b32 v9, v65 offset:1024
    ds_read_b32 v10, v65 offset:2048
    ds_read_b32 v11, v65 offset:3072
    ds_read_b128 v[72:75], v64 offset:0
    ds_read_b128 v[76:79], v64 offset:1024
    ds_read_b128 v[80:83], v64 offset:2048
    ds_read_b128 v[88:91], v64 offset:3072
    ds_read_b128 v[92:95], v64 offset:4096
    ds_read_b128 v[96:99], v64 offset:5120
    ds_read_b128 v[104:107], v64 offset:6144
    ds_read_b128 v[108:111], v64 offset:7168
    ds_read_b128 v[112:115], v64 offset:8192
    ds_read_b128 v[120:123], v64 offset:9216
    ds_read_b128 v[124:127], v64 offset:10240
    ds_read_b128 v[128:131], v64 offset:11264
    s_lshl_b32 s34, s26, 1
    s_mul_i32 s34, s34, 69632
    s_add_u32 s34, s34, 7864320
    v_bfe_u32 v19, v1, 4, 1
    v_mul_u32_u24 v19, 69632, v19
    v_and_b32 v18, 15, v1
    v_lshl_add_u32 v19, v18, 4, v19
    s_mul_i32 s35, s21, 5
    v_add_u32 v16, s35, v5
    v_lshrrev_b32 v17, 3, v16
    v_lshl_add_u32 v20, v17, 10, v19
    v_bfe_u32 v18, v16, 2, 1
    v_lshl_add_u32 v20, v18, 9, v20
    v_and_b32 v18, 1, v16
    v_lshl_add_u32 v20, v18, 8, v20
    v_bfe_u32 v18, v16, 1, 1
    v_lshl_add_u32 v20, v18, 3, v20
    v_add_u32 v16, 2, v16
    v_lshrrev_b32 v17, 3, v16
    v_lshl_add_u32 v21, v17, 10, v19
    v_bfe_u32 v18, v16, 2, 1
    v_lshl_add_u32 v21, v18, 9, v21
    v_and_b32 v18, 1, v16
    v_lshl_add_u32 v21, v18, 8, v21
    v_bfe_u32 v18, v16, 1, 1
    v_lshl_add_u32 v21, v18, 3, v21
    v_add_u32 v16, 2, v16
    v_lshrrev_b32 v17, 3, v16
    v_lshl_add_u32 v22, v17, 10, v19
    v_bfe_u32 v18, v16, 2, 1
    v_lshl_add_u32 v22, v18, 9, v22
    v_and_b32 v18, 1, v16
    v_lshl_add_u32 v22, v18, 8, v22
    v_bfe_u32 v18, v16, 1, 1
    v_lshl_add_u32 v22, v18, 3, v22
    s_waitcnt lgkmcnt(12)
    v_max3_f32 v24, v8, v9, v10
    v_max_f32 v24, v24, v11
    v_sub_f32 v8, v8, v24
    v_sub_f32 v9, v9, v24
    v_sub_f32 v10, v10, v24
    v_sub_f32 v11, v11, v24
    v_exp_f32 v8, v8
    v_exp_f32 v9, v9
    v_exp_f32 v10, v10
    v_exp_f32 v11, v11
    s_waitcnt lgkmcnt(0)
    v_mul_f32 v25, v80, v8
    v_fmac_f32 v25, v96, v9
    v_fmac_f32 v25, v112, v10
    v_fmac_f32 v25, v128, v11
    v_mov_b32 v26, v25
    s_nop 1
    v_permlane32_swap_b32 v25, v26
    s_nop 1
    v_rcp_f32 v26, v26
    s_nop 0
    v_mul_f32 v8, v8, v26
    v_mul_f32 v9, v9, v26
    v_mul_f32 v10, v10, v26
    v_mul_f32 v11, v11, v26
    v_mul_f32 v72, v72, v8
    v_fmac_f32 v72, v88, v9
    v_fmac_f32 v72, v104, v10
    v_fmac_f32 v72, v120, v11
    v_mul_f32 v73, v73, v8
    v_fmac_f32 v73, v89, v9
    v_fmac_f32 v73, v105, v10
    v_fmac_f32 v73, v121, v11
    v_mul_f32 v74, v74, v8
    v_fmac_f32 v74, v90, v9
    v_fmac_f32 v74, v106, v10
    v_fmac_f32 v74, v122, v11
    v_mul_f32 v75, v75, v8
    v_fmac_f32 v75, v91, v9
    v_fmac_f32 v75, v107, v10
    v_fmac_f32 v75, v123, v11
    v_cvt_pk_bf16_f32 v32, v72, v73
    v_cvt_pk_bf16_f32 v33, v74, v75
    buffer_store_dwordx2 v[32:33], v20, s[8:11], s34 offen
    v_mul_f32 v76, v76, v8
    v_fmac_f32 v76, v92, v9
    v_fmac_f32 v76, v108, v10
    v_fmac_f32 v76, v124, v11
    v_mul_f32 v77, v77, v8
    v_fmac_f32 v77, v93, v9
    v_fmac_f32 v77, v109, v10
    v_fmac_f32 v77, v125, v11
    v_mul_f32 v78, v78, v8
    v_fmac_f32 v78, v94, v9
    v_fmac_f32 v78, v110, v10
    v_fmac_f32 v78, v126, v11
    v_mul_f32 v79, v79, v8
    v_fmac_f32 v79, v95, v9
    v_fmac_f32 v79, v111, v10
    v_fmac_f32 v79, v127, v11
    v_cvt_pk_bf16_f32 v34, v76, v77
    v_cvt_pk_bf16_f32 v35, v78, v79
    buffer_store_dwordx2 v[34:35], v21, s[8:11], s34 offen
    v_mul_f32 v80, v80, v8
    v_fmac_f32 v80, v96, v9
    v_fmac_f32 v80, v112, v10
    v_fmac_f32 v80, v128, v11
    v_mul_f32 v81, v81, v8
    v_fmac_f32 v81, v97, v9
    v_fmac_f32 v81, v113, v10
    v_fmac_f32 v81, v129, v11
    v_mul_f32 v82, v82, v8
    v_fmac_f32 v82, v98, v9
    v_fmac_f32 v82, v114, v10
    v_fmac_f32 v82, v130, v11
    v_mul_f32 v83, v83, v8
    v_fmac_f32 v83, v99, v9
    v_fmac_f32 v83, v115, v10
    v_fmac_f32 v83, v131, v11
    v_cvt_pk_bf16_f32 v36, v80, v81
    v_cvt_pk_bf16_f32 v37, v82, v83
    s_mov_b64 exec, s[14:15]
    buffer_store_dwordx2 v[36:37], v22, s[8:11], s34 offen
    s_endpgm
LK2_ffn:
    s_waitcnt lgkmcnt(0)
    s_mov_b32 s8, s4
    s_mov_b32 s9, s5
    s_mov_b32 s10, 268435456
    s_mov_b32 s11, 0x00020000
    s_mov_b32 s12, s6
    s_mov_b32 s13, s7
    s_mov_b32 s14, 2621440
    s_mov_b32 s15, 0x00020000
LD:
    s_and_b32 s27, s3, 7
    s_lshr_b32 s28, s3, 3
    s_lshr_b32 s29, s27, 1
    s_lshl_b32 s29, s29, 3
    s_lshr_b32 s30, s28, 2
    s_add_u32 s29, s29, s30
    s_and_b32 s30, s27, 1
    s_lshl_b32 s30, s30, 2
    s_and_b32 s31, s28, 3
    s_add_u32 s30, s30, s31
    v_lshlrev_b32 v3, 4, v1
    v_add_u32 v4, 69632, v3
    v_add_u32 v5, 139264, v3
    v_add_u32 v6, 208896, v3
    v_add_u32 v7, 4096, v3
    s_mul_i32 s32, s20, 12
    s_add_u32 s32, s32, 20
    s_mul_i32 s33, s29, 278528
    s_lshl_b32 s34, s32, 10
    s_add_u32 s33, s33, s34
    s_add_u32 s33, s33, 7864320
    s_mul_i32 s34, s32, 40960
    s_mul_i32 s35, s30, 5120
    s_add_u32 s34, s34, s35
    s_add_u32 s34, s34, 16777216
    buffer_load_dwordx4 v[28:31], v3, s[8:11], s34 offen offset:0
    buffer_load_dwordx4 v[32:35], v3, s[8:11], s34 offen offset:1024
    buffer_load_dwordx4 v[36:39], v3, s[8:11], s34 offen offset:2048
    buffer_load_dwordx4 v[40:43], v3, s[8:11], s34 offen offset:3072
    buffer_load_dwordx4 v[44:47], v7, s[8:11], s34 offen
    s_add_u32 s34, s34, 40960
    buffer_load_dwordx4 v[12:15], v3, s[8:11], s33 offen
    buffer_load_dwordx4 v[16:19], v4, s[8:11], s33 offen
    buffer_load_dwordx4 v[20:23], v5, s[8:11], s33 offen
    buffer_load_dwordx4 v[24:27], v6, s[8:11], s33 offen
    s_add_u32 s33, s33, 1024
    buffer_load_dwordx4 v[64:67], v3, s[8:11], s34 offen offset:0
    buffer_load_dwordx4 v[68:71], v3, s[8:11], s34 offen offset:1024
    buffer_load_dwordx4 v[72:75], v3, s[8:11], s34 offen offset:2048
    buffer_load_dwordx4 v[76:79], v3, s[8:11], s34 offen offset:3072
    buffer_load_dwordx4 v[80:83], v7, s[8:11], s34 offen
    s_add_u32 s34, s34, 40960
    buffer_load_dwordx4 v[48:51], v3, s[8:11], s33 offen
    buffer_load_dwordx4 v[52:55], v4, s[8:11], s33 offen
    buffer_load_dwordx4 v[56:59], v5, s[8:11], s33 offen
    buffer_load_dwordx4 v[60:63], v6, s[8:11], s33 offen
    s_add_u32 s33, s33, 1024
    s_lshl_b32 s36, s29, 6
    s_lshl_b32 s37, s20, 4
    s_add_u32 s36, s36, s37
    v_and_b32 v8, 15, v1
    v_add_u32 v8, s36, v8
    v_mul_u32_u24 v8, 1280, v8
    v_lshrrev_b32 v9, 4, v1
    v_lshl_add_u32 v8, v9, 3, v8
    s_mul_i32 s36, s30, 160
    s_lshl_b32 s38, s29, 3
    s_add_u32 s38, s38, s30
    s_mul_i32 s38, s38, 20480
    s_mul_i32 s39, s20, 5120
    s_add_u32 s38, s38, s39
    s_add_u32 s38, s38, 20971520
    s_waitcnt vmcnt(9)
    s_setprio 0
    v_mfma_f32_16x16x32_bf16 v[88:91], v[28:31], v[12:15], 0
    v_mfma_f32_16x16x32_bf16 v[92:95], v[32:35], v[12:15], 0
    v_mfma_f32_16x16x32_bf16 v[96:99], v[36:39], v[12:15], 0
    v_mfma_f32_16x16x32_bf16 v[100:103], v[40:43], v[12:15], 0
    v_mfma_f32_16x16x32_bf16 v[104:107], v[44:47], v[12:15], 0
    v_mfma_f32_16x16x32_bf16 v[108:111], v[28:31], v[16:19], 0
    v_mfma_f32_16x16x32_bf16 v[112:115], v[32:35], v[16:19], 0
    v_mfma_f32_16x16x32_bf16 v[116:119], v[36:39], v[16:19], 0
    v_mfma_f32_16x16x32_bf16 v[120:123], v[40:43], v[16:19], 0
    v_mfma_f32_16x16x32_bf16 v[124:127], v[44:47], v[16:19], 0
    v_mfma_f32_16x16x32_bf16 v[128:131], v[28:31], v[20:23], 0
    v_mfma_f32_16x16x32_bf16 v[132:135], v[32:35], v[20:23], 0
    v_mfma_f32_16x16x32_bf16 v[136:139], v[36:39], v[20:23], 0
    v_mfma_f32_16x16x32_bf16 v[140:143], v[40:43], v[20:23], 0
    v_mfma_f32_16x16x32_bf16 v[144:147], v[44:47], v[20:23], 0
    v_mfma_f32_16x16x32_bf16 v[148:151], v[28:31], v[24:27], 0
    v_mfma_f32_16x16x32_bf16 v[152:155], v[32:35], v[24:27], 0
    v_mfma_f32_16x16x32_bf16 v[156:159], v[36:39], v[24:27], 0
    v_mfma_f32_16x16x32_bf16 v[160:163], v[40:43], v[24:27], 0
    v_mfma_f32_16x16x32_bf16 v[164:167], v[44:47], v[24:27], 0
    s_setprio 0
    buffer_load_dwordx4 v[28:31], v3, s[8:11], s34 offen offset:0
    buffer_load_dwordx4 v[32:35], v3, s[8:11], s34 offen offset:1024
    buffer_load_dwordx4 v[36:39], v3, s[8:11], s34 offen offset:2048
    buffer_load_dwordx4 v[40:43], v3, s[8:11], s34 offen offset:3072
    buffer_load_dwordx4 v[44:47], v7, s[8:11], s34 offen
    s_add_u32 s34, s34, 40960
    buffer_load_dwordx4 v[12:15], v3, s[8:11], s33 offen
    buffer_load_dwordx4 v[16:19], v4, s[8:11], s33 offen
    buffer_load_dwordx4 v[20:23], v5, s[8:11], s33 offen
    buffer_load_dwordx4 v[24:27], v6, s[8:11], s33 offen
    s_add_u32 s33, s33, 1024
    s_waitcnt vmcnt(9)
    s_setprio 0
    v_mfma_f32_16x16x32_bf16 v[88:91], v[64:67], v[48:51], v[88:91]
    v_mfma_f32_16x16x32_bf16 v[92:95], v[68:71], v[48:51], v[92:95]
    v_mfma_f32_16x16x32_bf16 v[96:99], v[72:75], v[48:51], v[96:99]
    v_mfma_f32_16x16x32_bf16 v[100:103], v[76:79], v[48:51], v[100:103]
    v_mfma_f32_16x16x32_bf16 v[104:107], v[80:83], v[48:51], v[104:107]
    v_mfma_f32_16x16x32_bf16 v[108:111], v[64:67], v[52:55], v[108:111]
    v_mfma_f32_16x16x32_bf16 v[112:115], v[68:71], v[52:55], v[112:115]
    v_mfma_f32_16x16x32_bf16 v[116:119], v[72:75], v[52:55], v[116:119]
    v_mfma_f32_16x16x32_bf16 v[120:123], v[76:79], v[52:55], v[120:123]
    v_mfma_f32_16x16x32_bf16 v[124:127], v[80:83], v[52:55], v[124:127]
    v_mfma_f32_16x16x32_bf16 v[128:131], v[64:67], v[56:59], v[128:131]
    v_mfma_f32_16x16x32_bf16 v[132:135], v[68:71], v[56:59], v[132:135]
    v_mfma_f32_16x16x32_bf16 v[136:139], v[72:75], v[56:59], v[136:139]
    v_mfma_f32_16x16x32_bf16 v[140:143], v[76:79], v[56:59], v[140:143]
    v_mfma_f32_16x16x32_bf16 v[144:147], v[80:83], v[56:59], v[144:147]
    v_mfma_f32_16x16x32_bf16 v[148:151], v[64:67], v[60:63], v[148:151]
    v_mfma_f32_16x16x32_bf16 v[152:155], v[68:71], v[60:63], v[152:155]
    v_mfma_f32_16x16x32_bf16 v[156:159], v[72:75], v[60:63], v[156:159]
    v_mfma_f32_16x16x32_bf16 v[160:163], v[76:79], v[60:63], v[160:163]
    v_mfma_f32_16x16x32_bf16 v[164:167], v[80:83], v[60:63], v[164:167]
    s_setprio 0
    buffer_load_dwordx4 v[64:67], v3, s[8:11], s34 offen offset:0
    buffer_load_dwordx4 v[68:71], v3, s[8:11], s34 offen offset:1024
    buffer_load_dwordx4 v[72:75], v3, s[8:11], s34 offen offset:2048
    buffer_load_dwordx4 v[76:79], v3, s[8:11], s34 offen offset:3072
    buffer_load_dwordx4 v[80:83], v7, s[8:11], s34 offen
    s_add_u32 s34, s34, 40960
    buffer_load_dwordx4 v[48:51], v3, s[8:11], s33 offen
    buffer_load_dwordx4 v[52:55], v4, s[8:11], s33 offen
    buffer_load_dwordx4 v[56:59], v5, s[8:11], s33 offen
    buffer_load_dwordx4 v[60:63], v6, s[8:11], s33 offen
    s_add_u32 s33, s33, 1024
    s_waitcnt vmcnt(9)
    s_setprio 0
    v_mfma_f32_16x16x32_bf16 v[88:91], v[28:31], v[12:15], v[88:91]
    v_mfma_f32_16x16x32_bf16 v[92:95], v[32:35], v[12:15], v[92:95]
    v_mfma_f32_16x16x32_bf16 v[96:99], v[36:39], v[12:15], v[96:99]
    v_mfma_f32_16x16x32_bf16 v[100:103], v[40:43], v[12:15], v[100:103]
    v_mfma_f32_16x16x32_bf16 v[104:107], v[44:47], v[12:15], v[104:107]
    v_mfma_f32_16x16x32_bf16 v[108:111], v[28:31], v[16:19], v[108:111]
    v_mfma_f32_16x16x32_bf16 v[112:115], v[32:35], v[16:19], v[112:115]
    v_mfma_f32_16x16x32_bf16 v[116:119], v[36:39], v[16:19], v[116:119]
    v_mfma_f32_16x16x32_bf16 v[120:123], v[40:43], v[16:19], v[120:123]
    v_mfma_f32_16x16x32_bf16 v[124:127], v[44:47], v[16:19], v[124:127]
    v_mfma_f32_16x16x32_bf16 v[128:131], v[28:31], v[20:23], v[128:131]
    v_mfma_f32_16x16x32_bf16 v[132:135], v[32:35], v[20:23], v[132:135]
    v_mfma_f32_16x16x32_bf16 v[136:139], v[36:39], v[20:23], v[136:139]
    v_mfma_f32_16x16x32_bf16 v[140:143], v[40:43], v[20:23], v[140:143]
    v_mfma_f32_16x16x32_bf16 v[144:147], v[44:47], v[20:23], v[144:147]
    v_mfma_f32_16x16x32_bf16 v[148:151], v[28:31], v[24:27], v[148:151]
    v_mfma_f32_16x16x32_bf16 v[152:155], v[32:35], v[24:27], v[152:155]
    v_mfma_f32_16x16x32_bf16 v[156:159], v[36:39], v[24:27], v[156:159]
    v_mfma_f32_16x16x32_bf16 v[160:163], v[40:43], v[24:27], v[160:163]
    v_mfma_f32_16x16x32_bf16 v[164:167], v[44:47], v[24:27], v[164:167]
    s_setprio 0
    buffer_load_dwordx4 v[28:31], v3, s[8:11], s34 offen offset:0
    buffer_load_dwordx4 v[32:35], v3, s[8:11], s34 offen offset:1024
    buffer_load_dwordx4 v[36:39], v3, s[8:11], s34 offen offset:2048
    buffer_load_dwordx4 v[40:43], v3, s[8:11], s34 offen offset:3072
    buffer_load_dwordx4 v[44:47], v7, s[8:11], s34 offen
    s_add_u32 s34, s34, 40960
    buffer_load_dwordx4 v[12:15], v3, s[8:11], s33 offen
    buffer_load_dwordx4 v[16:19], v4, s[8:11], s33 offen
    buffer_load_dwordx4 v[20:23], v5, s[8:11], s33 offen
    buffer_load_dwordx4 v[24:27], v6, s[8:11], s33 offen
    s_add_u32 s33, s33, 1024
    s_waitcnt vmcnt(9)
    s_setprio 0
    v_mfma_f32_16x16x32_bf16 v[88:91], v[64:67], v[48:51], v[88:91]
    v_mfma_f32_16x16x32_bf16 v[92:95], v[68:71], v[48:51], v[92:95]
    v_mfma_f32_16x16x32_bf16 v[96:99], v[72:75], v[48:51], v[96:99]
    v_mfma_f32_16x16x32_bf16 v[100:103], v[76:79], v[48:51], v[100:103]
    v_mfma_f32_16x16x32_bf16 v[104:107], v[80:83], v[48:51], v[104:107]
    v_mfma_f32_16x16x32_bf16 v[108:111], v[64:67], v[52:55], v[108:111]
    v_mfma_f32_16x16x32_bf16 v[112:115], v[68:71], v[52:55], v[112:115]
    v_mfma_f32_16x16x32_bf16 v[116:119], v[72:75], v[52:55], v[116:119]
    v_mfma_f32_16x16x32_bf16 v[120:123], v[76:79], v[52:55], v[120:123]
    v_mfma_f32_16x16x32_bf16 v[124:127], v[80:83], v[52:55], v[124:127]
    v_mfma_f32_16x16x32_bf16 v[128:131], v[64:67], v[56:59], v[128:131]
    v_mfma_f32_16x16x32_bf16 v[132:135], v[68:71], v[56:59], v[132:135]
    v_mfma_f32_16x16x32_bf16 v[136:139], v[72:75], v[56:59], v[136:139]
    v_mfma_f32_16x16x32_bf16 v[140:143], v[76:79], v[56:59], v[140:143]
    v_mfma_f32_16x16x32_bf16 v[144:147], v[80:83], v[56:59], v[144:147]
    v_mfma_f32_16x16x32_bf16 v[148:151], v[64:67], v[60:63], v[148:151]
    v_mfma_f32_16x16x32_bf16 v[152:155], v[68:71], v[60:63], v[152:155]
    v_mfma_f32_16x16x32_bf16 v[156:159], v[72:75], v[60:63], v[156:159]
    v_mfma_f32_16x16x32_bf16 v[160:163], v[76:79], v[60:63], v[160:163]
    v_mfma_f32_16x16x32_bf16 v[164:167], v[80:83], v[60:63], v[164:167]
    s_setprio 0
    buffer_load_dwordx4 v[64:67], v3, s[8:11], s34 offen offset:0
    buffer_load_dwordx4 v[68:71], v3, s[8:11], s34 offen offset:1024
    buffer_load_dwordx4 v[72:75], v3, s[8:11], s34 offen offset:2048
    buffer_load_dwordx4 v[76:79], v3, s[8:11], s34 offen offset:3072
    buffer_load_dwordx4 v[80:83], v7, s[8:11], s34 offen
    s_add_u32 s34, s34, 40960
    buffer_load_dwordx4 v[48:51], v3, s[8:11], s33 offen
    buffer_load_dwordx4 v[52:55], v4, s[8:11], s33 offen
    buffer_load_dwordx4 v[56:59], v5, s[8:11], s33 offen
    buffer_load_dwordx4 v[60:63], v6, s[8:11], s33 offen
    s_add_u32 s33, s33, 1024
    s_waitcnt vmcnt(9)
    s_setprio 0
    v_mfma_f32_16x16x32_bf16 v[88:91], v[28:31], v[12:15], v[88:91]
    v_mfma_f32_16x16x32_bf16 v[92:95], v[32:35], v[12:15], v[92:95]
    v_mfma_f32_16x16x32_bf16 v[96:99], v[36:39], v[12:15], v[96:99]
    v_mfma_f32_16x16x32_bf16 v[100:103], v[40:43], v[12:15], v[100:103]
    v_mfma_f32_16x16x32_bf16 v[104:107], v[44:47], v[12:15], v[104:107]
    v_mfma_f32_16x16x32_bf16 v[108:111], v[28:31], v[16:19], v[108:111]
    v_mfma_f32_16x16x32_bf16 v[112:115], v[32:35], v[16:19], v[112:115]
    v_mfma_f32_16x16x32_bf16 v[116:119], v[36:39], v[16:19], v[116:119]
    v_mfma_f32_16x16x32_bf16 v[120:123], v[40:43], v[16:19], v[120:123]
    v_mfma_f32_16x16x32_bf16 v[124:127], v[44:47], v[16:19], v[124:127]
    v_mfma_f32_16x16x32_bf16 v[128:131], v[28:31], v[20:23], v[128:131]
    v_mfma_f32_16x16x32_bf16 v[132:135], v[32:35], v[20:23], v[132:135]
    v_mfma_f32_16x16x32_bf16 v[136:139], v[36:39], v[20:23], v[136:139]
    v_mfma_f32_16x16x32_bf16 v[140:143], v[40:43], v[20:23], v[140:143]
    v_mfma_f32_16x16x32_bf16 v[144:147], v[44:47], v[20:23], v[144:147]
    v_mfma_f32_16x16x32_bf16 v[148:151], v[28:31], v[24:27], v[148:151]
    v_mfma_f32_16x16x32_bf16 v[152:155], v[32:35], v[24:27], v[152:155]
    v_mfma_f32_16x16x32_bf16 v[156:159], v[36:39], v[24:27], v[156:159]
    v_mfma_f32_16x16x32_bf16 v[160:163], v[40:43], v[24:27], v[160:163]
    v_mfma_f32_16x16x32_bf16 v[164:167], v[44:47], v[24:27], v[164:167]
    s_setprio 0
    buffer_load_dwordx4 v[28:31], v3, s[8:11], s34 offen offset:0
    buffer_load_dwordx4 v[32:35], v3, s[8:11], s34 offen offset:1024
    buffer_load_dwordx4 v[36:39], v3, s[8:11], s34 offen offset:2048
    buffer_load_dwordx4 v[40:43], v3, s[8:11], s34 offen offset:3072
    buffer_load_dwordx4 v[44:47], v7, s[8:11], s34 offen
    s_add_u32 s34, s34, 40960
    buffer_load_dwordx4 v[12:15], v3, s[8:11], s33 offen
    buffer_load_dwordx4 v[16:19], v4, s[8:11], s33 offen
    buffer_load_dwordx4 v[20:23], v5, s[8:11], s33 offen
    buffer_load_dwordx4 v[24:27], v6, s[8:11], s33 offen
    s_add_u32 s33, s33, 1024
    s_waitcnt vmcnt(9)
    s_setprio 0
    v_mfma_f32_16x16x32_bf16 v[88:91], v[64:67], v[48:51], v[88:91]
    v_mfma_f32_16x16x32_bf16 v[92:95], v[68:71], v[48:51], v[92:95]
    v_mfma_f32_16x16x32_bf16 v[96:99], v[72:75], v[48:51], v[96:99]
    v_mfma_f32_16x16x32_bf16 v[100:103], v[76:79], v[48:51], v[100:103]
    v_mfma_f32_16x16x32_bf16 v[104:107], v[80:83], v[48:51], v[104:107]
    v_mfma_f32_16x16x32_bf16 v[108:111], v[64:67], v[52:55], v[108:111]
    v_mfma_f32_16x16x32_bf16 v[112:115], v[68:71], v[52:55], v[112:115]
    v_mfma_f32_16x16x32_bf16 v[116:119], v[72:75], v[52:55], v[116:119]
    v_mfma_f32_16x16x32_bf16 v[120:123], v[76:79], v[52:55], v[120:123]
    v_mfma_f32_16x16x32_bf16 v[124:127], v[80:83], v[52:55], v[124:127]
    v_mfma_f32_16x16x32_bf16 v[128:131], v[64:67], v[56:59], v[128:131]
    v_mfma_f32_16x16x32_bf16 v[132:135], v[68:71], v[56:59], v[132:135]
    v_mfma_f32_16x16x32_bf16 v[136:139], v[72:75], v[56:59], v[136:139]
    v_mfma_f32_16x16x32_bf16 v[140:143], v[76:79], v[56:59], v[140:143]
    v_mfma_f32_16x16x32_bf16 v[144:147], v[80:83], v[56:59], v[144:147]
    v_mfma_f32_16x16x32_bf16 v[148:151], v[64:67], v[60:63], v[148:151]
    v_mfma_f32_16x16x32_bf16 v[152:155], v[68:71], v[60:63], v[152:155]
    v_mfma_f32_16x16x32_bf16 v[156:159], v[72:75], v[60:63], v[156:159]
    v_mfma_f32_16x16x32_bf16 v[160:163], v[76:79], v[60:63], v[160:163]
    v_mfma_f32_16x16x32_bf16 v[164:167], v[80:83], v[60:63], v[164:167]
    s_setprio 0
    buffer_load_dwordx4 v[64:67], v3, s[8:11], s34 offen offset:0
    buffer_load_dwordx4 v[68:71], v3, s[8:11], s34 offen offset:1024
    buffer_load_dwordx4 v[72:75], v3, s[8:11], s34 offen offset:2048
    buffer_load_dwordx4 v[76:79], v3, s[8:11], s34 offen offset:3072
    buffer_load_dwordx4 v[80:83], v7, s[8:11], s34 offen
    s_add_u32 s34, s34, 40960
    buffer_load_dwordx4 v[48:51], v3, s[8:11], s33 offen
    buffer_load_dwordx4 v[52:55], v4, s[8:11], s33 offen
    buffer_load_dwordx4 v[56:59], v5, s[8:11], s33 offen
    buffer_load_dwordx4 v[60:63], v6, s[8:11], s33 offen
    s_add_u32 s33, s33, 1024
    s_waitcnt vmcnt(9)
    s_setprio 0
    v_mfma_f32_16x16x32_bf16 v[88:91], v[28:31], v[12:15], v[88:91]
    v_mfma_f32_16x16x32_bf16 v[92:95], v[32:35], v[12:15], v[92:95]
    v_mfma_f32_16x16x32_bf16 v[96:99], v[36:39], v[12:15], v[96:99]
    v_mfma_f32_16x16x32_bf16 v[100:103], v[40:43], v[12:15], v[100:103]
    v_mfma_f32_16x16x32_bf16 v[104:107], v[44:47], v[12:15], v[104:107]
    v_mfma_f32_16x16x32_bf16 v[108:111], v[28:31], v[16:19], v[108:111]
    v_mfma_f32_16x16x32_bf16 v[112:115], v[32:35], v[16:19], v[112:115]
    v_mfma_f32_16x16x32_bf16 v[116:119], v[36:39], v[16:19], v[116:119]
    v_mfma_f32_16x16x32_bf16 v[120:123], v[40:43], v[16:19], v[120:123]
    v_mfma_f32_16x16x32_bf16 v[124:127], v[44:47], v[16:19], v[124:127]
    v_mfma_f32_16x16x32_bf16 v[128:131], v[28:31], v[20:23], v[128:131]
    v_mfma_f32_16x16x32_bf16 v[132:135], v[32:35], v[20:23], v[132:135]
    v_mfma_f32_16x16x32_bf16 v[136:139], v[36:39], v[20:23], v[136:139]
    v_mfma_f32_16x16x32_bf16 v[140:143], v[40:43], v[20:23], v[140:143]
    v_mfma_f32_16x16x32_bf16 v[144:147], v[44:47], v[20:23], v[144:147]
    v_mfma_f32_16x16x32_bf16 v[148:151], v[28:31], v[24:27], v[148:151]
    v_mfma_f32_16x16x32_bf16 v[152:155], v[32:35], v[24:27], v[152:155]
    v_mfma_f32_16x16x32_bf16 v[156:159], v[36:39], v[24:27], v[156:159]
    v_mfma_f32_16x16x32_bf16 v[160:163], v[40:43], v[24:27], v[160:163]
    v_mfma_f32_16x16x32_bf16 v[164:167], v[44:47], v[24:27], v[164:167]
    s_setprio 0
    buffer_load_dwordx4 v[28:31], v3, s[8:11], s34 offen offset:0
    buffer_load_dwordx4 v[32:35], v3, s[8:11], s34 offen offset:1024
    buffer_load_dwordx4 v[36:39], v3, s[8:11], s34 offen offset:2048
    buffer_load_dwordx4 v[40:43], v3, s[8:11], s34 offen offset:3072
    buffer_load_dwordx4 v[44:47], v7, s[8:11], s34 offen
    s_add_u32 s34, s34, 40960
    buffer_load_dwordx4 v[12:15], v3, s[8:11], s33 offen
    buffer_load_dwordx4 v[16:19], v4, s[8:11], s33 offen
    buffer_load_dwordx4 v[20:23], v5, s[8:11], s33 offen
    buffer_load_dwordx4 v[24:27], v6, s[8:11], s33 offen
    s_add_u32 s33, s33, 1024
    s_waitcnt vmcnt(9)
    s_setprio 0
    v_mfma_f32_16x16x32_bf16 v[88:91], v[64:67], v[48:51], v[88:91]
    v_mfma_f32_16x16x32_bf16 v[92:95], v[68:71], v[48:51], v[92:95]
    v_mfma_f32_16x16x32_bf16 v[96:99], v[72:75], v[48:51], v[96:99]
    v_mfma_f32_16x16x32_bf16 v[100:103], v[76:79], v[48:51], v[100:103]
    v_mfma_f32_16x16x32_bf16 v[104:107], v[80:83], v[48:51], v[104:107]
    v_mfma_f32_16x16x32_bf16 v[108:111], v[64:67], v[52:55], v[108:111]
    v_mfma_f32_16x16x32_bf16 v[112:115], v[68:71], v[52:55], v[112:115]
    v_mfma_f32_16x16x32_bf16 v[116:119], v[72:75], v[52:55], v[116:119]
    v_mfma_f32_16x16x32_bf16 v[120:123], v[76:79], v[52:55], v[120:123]
    v_mfma_f32_16x16x32_bf16 v[124:127], v[80:83], v[52:55], v[124:127]
    v_mfma_f32_16x16x32_bf16 v[128:131], v[64:67], v[56:59], v[128:131]
    v_mfma_f32_16x16x32_bf16 v[132:135], v[68:71], v[56:59], v[132:135]
    v_mfma_f32_16x16x32_bf16 v[136:139], v[72:75], v[56:59], v[136:139]
    v_mfma_f32_16x16x32_bf16 v[140:143], v[76:79], v[56:59], v[140:143]
    v_mfma_f32_16x16x32_bf16 v[144:147], v[80:83], v[56:59], v[144:147]
    v_mfma_f32_16x16x32_bf16 v[148:151], v[64:67], v[60:63], v[148:151]
    v_mfma_f32_16x16x32_bf16 v[152:155], v[68:71], v[60:63], v[152:155]
    v_mfma_f32_16x16x32_bf16 v[156:159], v[72:75], v[60:63], v[156:159]
    v_mfma_f32_16x16x32_bf16 v[160:163], v[76:79], v[60:63], v[160:163]
    v_mfma_f32_16x16x32_bf16 v[164:167], v[80:83], v[60:63], v[164:167]
    s_setprio 0
    buffer_load_dwordx4 v[64:67], v3, s[8:11], s34 offen offset:0
    buffer_load_dwordx4 v[68:71], v3, s[8:11], s34 offen offset:1024
    buffer_load_dwordx4 v[72:75], v3, s[8:11], s34 offen offset:2048
    buffer_load_dwordx4 v[76:79], v3, s[8:11], s34 offen offset:3072
    buffer_load_dwordx4 v[80:83], v7, s[8:11], s34 offen
    s_add_u32 s34, s34, 40960
    buffer_load_dwordx4 v[48:51], v3, s[8:11], s33 offen
    buffer_load_dwordx4 v[52:55], v4, s[8:11], s33 offen
    buffer_load_dwordx4 v[56:59], v5, s[8:11], s33 offen
    buffer_load_dwordx4 v[60:63], v6, s[8:11], s33 offen
    s_add_u32 s33, s33, 1024
    s_waitcnt vmcnt(9)
    s_setprio 0
    v_mfma_f32_16x16x32_bf16 v[88:91], v[28:31], v[12:15], v[88:91]
    v_mfma_f32_16x16x32_bf16 v[92:95], v[32:35], v[12:15], v[92:95]
    v_mfma_f32_16x16x32_bf16 v[96:99], v[36:39], v[12:15], v[96:99]
    v_mfma_f32_16x16x32_bf16 v[100:103], v[40:43], v[12:15], v[100:103]
    v_mfma_f32_16x16x32_bf16 v[104:107], v[44:47], v[12:15], v[104:107]
    v_mfma_f32_16x16x32_bf16 v[108:111], v[28:31], v[16:19], v[108:111]
    v_mfma_f32_16x16x32_bf16 v[112:115], v[32:35], v[16:19], v[112:115]
    v_mfma_f32_16x16x32_bf16 v[116:119], v[36:39], v[16:19], v[116:119]
    v_mfma_f32_16x16x32_bf16 v[120:123], v[40:43], v[16:19], v[120:123]
    v_mfma_f32_16x16x32_bf16 v[124:127], v[44:47], v[16:19], v[124:127]
    v_mfma_f32_16x16x32_bf16 v[128:131], v[28:31], v[20:23], v[128:131]
    v_mfma_f32_16x16x32_bf16 v[132:135], v[32:35], v[20:23], v[132:135]
    v_mfma_f32_16x16x32_bf16 v[136:139], v[36:39], v[20:23], v[136:139]
    v_mfma_f32_16x16x32_bf16 v[140:143], v[40:43], v[20:23], v[140:143]
    v_mfma_f32_16x16x32_bf16 v[144:147], v[44:47], v[20:23], v[144:147]
    v_mfma_f32_16x16x32_bf16 v[148:151], v[28:31], v[24:27], v[148:151]
    v_mfma_f32_16x16x32_bf16 v[152:155], v[32:35], v[24:27], v[152:155]
    v_mfma_f32_16x16x32_bf16 v[156:159], v[36:39], v[24:27], v[156:159]
    v_mfma_f32_16x16x32_bf16 v[160:163], v[40:43], v[24:27], v[160:163]
    v_mfma_f32_16x16x32_bf16 v[164:167], v[44:47], v[24:27], v[164:167]
    s_setprio 0
    buffer_load_dwordx4 v[28:31], v3, s[8:11], s34 offen offset:0
    buffer_load_dwordx4 v[32:35], v3, s[8:11], s34 offen offset:1024
    buffer_load_dwordx4 v[36:39], v3, s[8:11], s34 offen offset:2048
    buffer_load_dwordx4 v[40:43], v3, s[8:11], s34 offen offset:3072
    buffer_load_dwordx4 v[44:47], v7, s[8:11], s34 offen
    s_add_u32 s34, s34, 40960
    buffer_load_dwordx4 v[12:15], v3, s[8:11], s33 offen
    buffer_load_dwordx4 v[16:19], v4, s[8:11], s33 offen
    buffer_load_dwordx4 v[20:23], v5, s[8:11], s33 offen
    buffer_load_dwordx4 v[24:27], v6, s[8:11], s33 offen
    s_add_u32 s33, s33, 1024
    s_waitcnt vmcnt(9)
    s_setprio 0
    v_mfma_f32_16x16x32_bf16 v[88:91], v[64:67], v[48:51], v[88:91]
    v_mfma_f32_16x16x32_bf16 v[92:95], v[68:71], v[48:51], v[92:95]
    v_mfma_f32_16x16x32_bf16 v[96:99], v[72:75], v[48:51], v[96:99]
    v_mfma_f32_16x16x32_bf16 v[100:103], v[76:79], v[48:51], v[100:103]
    v_mfma_f32_16x16x32_bf16 v[104:107], v[80:83], v[48:51], v[104:107]
    v_mfma_f32_16x16x32_bf16 v[108:111], v[64:67], v[52:55], v[108:111]
    v_mfma_f32_16x16x32_bf16 v[112:115], v[68:71], v[52:55], v[112:115]
    v_mfma_f32_16x16x32_bf16 v[116:119], v[72:75], v[52:55], v[116:119]
    v_mfma_f32_16x16x32_bf16 v[120:123], v[76:79], v[52:55], v[120:123]
    v_mfma_f32_16x16x32_bf16 v[124:127], v[80:83], v[52:55], v[124:127]
    v_mfma_f32_16x16x32_bf16 v[128:131], v[64:67], v[56:59], v[128:131]
    v_mfma_f32_16x16x32_bf16 v[132:135], v[68:71], v[56:59], v[132:135]
    v_mfma_f32_16x16x32_bf16 v[136:139], v[72:75], v[56:59], v[136:139]
    v_mfma_f32_16x16x32_bf16 v[140:143], v[76:79], v[56:59], v[140:143]
    v_mfma_f32_16x16x32_bf16 v[144:147], v[80:83], v[56:59], v[144:147]
    v_mfma_f32_16x16x32_bf16 v[148:151], v[64:67], v[60:63], v[148:151]
    v_mfma_f32_16x16x32_bf16 v[152:155], v[68:71], v[60:63], v[152:155]
    v_mfma_f32_16x16x32_bf16 v[156:159], v[72:75], v[60:63], v[156:159]
    v_mfma_f32_16x16x32_bf16 v[160:163], v[76:79], v[60:63], v[160:163]
    v_mfma_f32_16x16x32_bf16 v[164:167], v[80:83], v[60:63], v[164:167]
    s_setprio 0
    buffer_load_dwordx4 v[64:67], v3, s[8:11], s34 offen offset:0
    buffer_load_dwordx4 v[68:71], v3, s[8:11], s34 offen offset:1024
    buffer_load_dwordx4 v[72:75], v3, s[8:11], s34 offen offset:2048
    buffer_load_dwordx4 v[76:79], v3, s[8:11], s34 offen offset:3072
    buffer_load_dwordx4 v[80:83], v7, s[8:11], s34 offen
    s_add_u32 s34, s34, 40960
    buffer_load_dwordx4 v[48:51], v3, s[8:11], s33 offen
    buffer_load_dwordx4 v[52:55], v4, s[8:11], s33 offen
    buffer_load_dwordx4 v[56:59], v5, s[8:11], s33 offen
    buffer_load_dwordx4 v[60:63], v6, s[8:11], s33 offen
    s_add_u32 s33, s33, 1024
    s_waitcnt vmcnt(9)
    s_setprio 0
    v_mfma_f32_16x16x32_bf16 v[88:91], v[28:31], v[12:15], v[88:91]
    v_mfma_f32_16x16x32_bf16 v[92:95], v[32:35], v[12:15], v[92:95]
    v_mfma_f32_16x16x32_bf16 v[96:99], v[36:39], v[12:15], v[96:99]
    v_mfma_f32_16x16x32_bf16 v[100:103], v[40:43], v[12:15], v[100:103]
    v_mfma_f32_16x16x32_bf16 v[104:107], v[44:47], v[12:15], v[104:107]
    v_mfma_f32_16x16x32_bf16 v[108:111], v[28:31], v[16:19], v[108:111]
    v_mfma_f32_16x16x32_bf16 v[112:115], v[32:35], v[16:19], v[112:115]
    v_mfma_f32_16x16x32_bf16 v[116:119], v[36:39], v[16:19], v[116:119]
    v_mfma_f32_16x16x32_bf16 v[120:123], v[40:43], v[16:19], v[120:123]
    v_mfma_f32_16x16x32_bf16 v[124:127], v[44:47], v[16:19], v[124:127]
    v_mfma_f32_16x16x32_bf16 v[128:131], v[28:31], v[20:23], v[128:131]
    v_mfma_f32_16x16x32_bf16 v[132:135], v[32:35], v[20:23], v[132:135]
    v_mfma_f32_16x16x32_bf16 v[136:139], v[36:39], v[20:23], v[136:139]
    v_mfma_f32_16x16x32_bf16 v[140:143], v[40:43], v[20:23], v[140:143]
    v_mfma_f32_16x16x32_bf16 v[144:147], v[44:47], v[20:23], v[144:147]
    v_mfma_f32_16x16x32_bf16 v[148:151], v[28:31], v[24:27], v[148:151]
    v_mfma_f32_16x16x32_bf16 v[152:155], v[32:35], v[24:27], v[152:155]
    v_mfma_f32_16x16x32_bf16 v[156:159], v[36:39], v[24:27], v[156:159]
    v_mfma_f32_16x16x32_bf16 v[160:163], v[40:43], v[24:27], v[160:163]
    v_mfma_f32_16x16x32_bf16 v[164:167], v[44:47], v[24:27], v[164:167]
    s_waitcnt vmcnt(0)
    s_setprio 0
    v_mfma_f32_16x16x32_bf16 v[88:91], v[64:67], v[48:51], v[88:91]
    v_mfma_f32_16x16x32_bf16 v[92:95], v[68:71], v[48:51], v[92:95]
    v_mfma_f32_16x16x32_bf16 v[96:99], v[72:75], v[48:51], v[96:99]
    v_mfma_f32_16x16x32_bf16 v[100:103], v[76:79], v[48:51], v[100:103]
    v_mfma_f32_16x16x32_bf16 v[104:107], v[80:83], v[48:51], v[104:107]
    v_mfma_f32_16x16x32_bf16 v[108:111], v[64:67], v[52:55], v[108:111]
    v_mfma_f32_16x16x32_bf16 v[112:115], v[68:71], v[52:55], v[112:115]
    v_mfma_f32_16x16x32_bf16 v[116:119], v[72:75], v[52:55], v[116:119]
    v_mfma_f32_16x16x32_bf16 v[120:123], v[76:79], v[52:55], v[120:123]
    v_mfma_f32_16x16x32_bf16 v[124:127], v[80:83], v[52:55], v[124:127]
    v_mfma_f32_16x16x32_bf16 v[128:131], v[64:67], v[56:59], v[128:131]
    v_mfma_f32_16x16x32_bf16 v[132:135], v[68:71], v[56:59], v[132:135]
    v_mfma_f32_16x16x32_bf16 v[136:139], v[72:75], v[56:59], v[136:139]
    v_mfma_f32_16x16x32_bf16 v[140:143], v[76:79], v[56:59], v[140:143]
    v_mfma_f32_16x16x32_bf16 v[144:147], v[80:83], v[56:59], v[144:147]
    v_mfma_f32_16x16x32_bf16 v[148:151], v[64:67], v[60:63], v[148:151]
    v_mfma_f32_16x16x32_bf16 v[152:155], v[68:71], v[60:63], v[152:155]
    v_mfma_f32_16x16x32_bf16 v[156:159], v[72:75], v[60:63], v[156:159]
    v_mfma_f32_16x16x32_bf16 v[160:163], v[76:79], v[60:63], v[160:163]
    v_mfma_f32_16x16x32_bf16 v[164:167], v[80:83], v[60:63], v[164:167]
    buffer_load_dwordx2 v[12:13], v8, s[12:15], s36 offen offset:0
    buffer_load_dwordx2 v[14:15], v8, s[12:15], s36 offen offset:32
    buffer_load_dwordx2 v[16:17], v8, s[12:15], s36 offen offset:64
    buffer_load_dwordx2 v[18:19], v8, s[12:15], s36 offen offset:96
    buffer_load_dwordx2 v[20:21], v8, s[12:15], s36 offen offset:128
    s_nop 3
    s_mul_i32 s37, s20, 9216
    v_add_u32 v9, s37, v3
    s_cmp_eq_u32 s20, 0
    s_cbranch_scc0 LD_r0n0
    ds_write_b128 v3, v[108:111] offset:9216
    ds_write_b128 v3, v[112:115] offset:10240
    ds_write_b128 v3, v[116:119] offset:11264
    ds_write_b128 v3, v[128:131] offset:18432
    ds_write_b128 v3, v[132:135] offset:19456
    ds_write_b128 v3, v[136:139] offset:20480
    ds_write_b128 v3, v[148:151] offset:27648
    ds_write_b128 v3, v[152:155] offset:28672
    ds_write_b128 v3, v[156:159] offset:29696
    v_mov_b32 v32, v88
    v_mov_b32 v33, v89
    v_mov_b32 v34, v90
    v_mov_b32 v35, v91
    v_mov_b32 v36, v92
    v_mov_b32 v37, v93
    v_mov_b32 v38, v94
    v_mov_b32 v39, v95
    v_mov_b32 v40, v96
    v_mov_b32 v41, v97
    v_mov_b32 v42, v98
    v_mov_b32 v43, v99
    s_branch LD_r0d
LD_r0n0:
    s_cmp_eq_u32 s20, 1
    s_cbranch_scc0 LD_r0n1
    ds_write_b128 v3, v[88:91] offset:0
    ds_write_b128 v3, v[92:95] offset:1024
    ds_write_b128 v3, v[96:99] offset:2048
    ds_write_b128 v3, v[128:131] offset:21504
    ds_write_b128 v3, v[132:135] offset:22528
    ds_write_b128 v3, v[136:139] offset:23552
    ds_write_b128 v3, v[148:151] offset:30720
    ds_write_b128 v3, v[152:155] offset:31744
    ds_write_b128 v3, v[156:159] offset:32768
    v_mov_b32 v32, v108
    v_mov_b32 v33, v109
    v_mov_b32 v34, v110
    v_mov_b32 v35, v111
    v_mov_b32 v36, v112
    v_mov_b32 v37, v113
    v_mov_b32 v38, v114
    v_mov_b32 v39, v115
    v_mov_b32 v40, v116
    v_mov_b32 v41, v117
    v_mov_b32 v42, v118
    v_mov_b32 v43, v119
    s_branch LD_r0d
LD_r0n1:
    s_cmp_eq_u32 s20, 2
    s_cbranch_scc0 LD_r0n2
    ds_write_b128 v3, v[88:91] offset:3072
    ds_write_b128 v3, v[92:95] offset:4096
    ds_write_b128 v3, v[96:99] offset:5120
    ds_write_b128 v3, v[108:111] offset:12288
    ds_write_b128 v3, v[112:115] offset:13312
    ds_write_b128 v3, v[116:119] offset:14336
    ds_write_b128 v3, v[148:151] offset:33792
    ds_write_b128 v3, v[152:155] offset:34816
    ds_write_b128 v3, v[156:159] offset:35840
    v_mov_b32 v32, v128
    v_mov_b32 v33, v129
    v_mov_b32 v34, v130
    v_mov_b32 v35, v131
    v_mov_b32 v36, v132
    v_mov_b32 v37, v133
    v_mov_b32 v38, v134
    v_mov_b32 v39, v135
    v_mov_b32 v40, v136
    v_mov_b32 v41, v137
    v_mov_b32 v42, v138
    v_mov_b32 v43, v139
    s_branch LD_r0d
LD_r0n2:
    ds_write_b128 v3, v[88:91] offset:6144
    ds_write_b128 v3, v[92:95] offset:7168
    ds_write_b128 v3, v[96:99] offset:8192
    ds_write_b128 v3, v[108:111] offset:15360
    ds_write_b128 v3, v[112:115] offset:16384
    ds_write_b128 v3, v[116:119] offset:17408
    ds_write_b128 v3, v[128:131] offset:24576
    ds_write_b128 v3, v[132:135] offset:25600
    ds_write_b128 v3, v[136:139] offset:26624
    v_mov_b32 v32, v148
    v_mov_b32 v33, v149
    v_mov_b32 v34, v150
    v_mov_b32 v35, v151
    v_mov_b32 v36, v152
    v_mov_b32 v37, v153
    v_mov_b32 v38, v154
    v_mov_b32 v39, v155
    v_mov_b32 v40, v156
    v_mov_b32 v41, v157
    v_mov_b32 v42, v158
    v_mov_b32 v43, v159
LD_r0d:
    s_waitcnt lgkmcnt(0)
    s_barrier
    ds_read_b128 v[52:55], v9 offset:0
    ds_read_b128 v[56:59], v9 offset:1024
    ds_read_b128 v[60:63], v9 offset:2048
    ds_read_b128 v[64:67], v9 offset:3072
    ds_read_b128 v[68:71], v9 offset:4096
    ds_read_b128 v[72:75], v9 offset:5120
    s_waitcnt lgkmcnt(3)
    v_add_f32 v32, v32, v52
    v_add_f32 v33, v33, v53
    v_add_f32 v34, v34, v54
    v_add_f32 v35, v35, v55
    v_add_f32 v36, v36, v56
    v_add_f32 v37, v37, v57
    v_add_f32 v38, v38, v58
    v_add_f32 v39, v39, v59
    v_add_f32 v40, v40, v60
    v_add_f32 v41, v41, v61
    v_add_f32 v42, v42, v62
    v_add_f32 v43, v43, v63
    ds_read_b128 v[52:55], v9 offset:6144
    ds_read_b128 v[56:59], v9 offset:7168
    ds_read_b128 v[60:63], v9 offset:8192
    s_waitcnt lgkmcnt(3)
    v_add_f32 v32, v32, v64
    v_add_f32 v33, v33, v65
    v_add_f32 v34, v34, v66
    v_add_f32 v35, v35, v67
    v_add_f32 v36, v36, v68
    v_add_f32 v37, v37, v69
    v_add_f32 v38, v38, v70
    v_add_f32 v39, v39, v71
    v_add_f32 v40, v40, v72
    v_add_f32 v41, v41, v73
    v_add_f32 v42, v42, v74
    v_add_f32 v43, v43, v75
    s_waitcnt lgkmcnt(0)
    v_add_f32 v32, v32, v52
    v_add_f32 v33, v33, v53
    v_add_f32 v34, v34, v54
    v_add_f32 v35, v35, v55
    v_add_f32 v36, v36, v56
    v_add_f32 v37, v37, v57
    v_add_f32 v38, v38, v58
    v_add_f32 v39, v39, v59
    v_add_f32 v40, v40, v60
    v_add_f32 v41, v41, v61
    v_add_f32 v42, v42, v62
    v_add_f32 v43, v43, v63
    s_barrier
    s_cmp_eq_u32 s20, 0
    s_cbranch_scc0 LD_r1n0
    ds_write_b128 v3, v[120:123] offset:9216
    ds_write_b128 v3, v[124:127] offset:10240
    ds_write_b128 v3, v[140:143] offset:18432
    ds_write_b128 v3, v[144:147] offset:19456
    ds_write_b128 v3, v[160:163] offset:27648
    ds_write_b128 v3, v[164:167] offset:28672
    v_mov_b32 v44, v100
    v_mov_b32 v45, v101
    v_mov_b32 v46, v102
    v_mov_b32 v47, v103
    v_mov_b32 v48, v104
    v_mov_b32 v49, v105
    v_mov_b32 v50, v106
    v_mov_b32 v51, v107
    s_branch LD_r1d
LD_r1n0:
    s_cmp_eq_u32 s20, 1
    s_cbranch_scc0 LD_r1n1
    ds_write_b128 v3, v[100:103] offset:0
    ds_write_b128 v3, v[104:107] offset:1024
    ds_write_b128 v3, v[140:143] offset:21504
    ds_write_b128 v3, v[144:147] offset:22528
    ds_write_b128 v3, v[160:163] offset:30720
    ds_write_b128 v3, v[164:167] offset:31744
    v_mov_b32 v44, v120
    v_mov_b32 v45, v121
    v_mov_b32 v46, v122
    v_mov_b32 v47, v123
    v_mov_b32 v48, v124
    v_mov_b32 v49, v125
    v_mov_b32 v50, v126
    v_mov_b32 v51, v127
    s_branch LD_r1d
LD_r1n1:
    s_cmp_eq_u32 s20, 2
    s_cbranch_scc0 LD_r1n2
    ds_write_b128 v3, v[100:103] offset:3072
    ds_write_b128 v3, v[104:107] offset:4096
    ds_write_b128 v3, v[120:123] offset:12288
    ds_write_b128 v3, v[124:127] offset:13312
    ds_write_b128 v3, v[160:163] offset:33792
    ds_write_b128 v3, v[164:167] offset:34816
    v_mov_b32 v44, v140
    v_mov_b32 v45, v141
    v_mov_b32 v46, v142
    v_mov_b32 v47, v143
    v_mov_b32 v48, v144
    v_mov_b32 v49, v145
    v_mov_b32 v50, v146
    v_mov_b32 v51, v147
    s_branch LD_r1d
LD_r1n2:
    ds_write_b128 v3, v[100:103] offset:6144
    ds_write_b128 v3, v[104:107] offset:7168
    ds_write_b128 v3, v[120:123] offset:15360
    ds_write_b128 v3, v[124:127] offset:16384
    ds_write_b128 v3, v[140:143] offset:24576
    ds_write_b128 v3, v[144:147] offset:25600
    v_mov_b32 v44, v160
    v_mov_b32 v45, v161
    v_mov_b32 v46, v162
    v_mov_b32 v47, v163
    v_mov_b32 v48, v164
    v_mov_b32 v49, v165
    v_mov_b32 v50, v166
    v_mov_b32 v51, v167
LD_r1d:
    s_waitcnt lgkmcnt(0)
    s_barrier
    ds_read_b128 v[52:55], v9 offset:0
    ds_read_b128 v[56:59], v9 offset:1024
    ds_read_b128 v[64:67], v9 offset:3072
    ds_read_b128 v[68:71], v9 offset:4096
    s_waitcnt lgkmcnt(2)
    v_add_f32 v44, v44, v52
    v_add_f32 v45, v45, v53
    v_add_f32 v46, v46, v54
    v_add_f32 v47, v47, v55
    v_add_f32 v48, v48, v56
    v_add_f32 v49, v49, v57
    v_add_f32 v50, v50, v58
    v_add_f32 v51, v51, v59
    ds_read_b128 v[52:55], v9 offset:6144
    ds_read_b128 v[56:59], v9 offset:7168
    s_waitcnt lgkmcnt(2)
    v_add_f32 v44, v44, v64
    v_add_f32 v45, v45, v65
    v_add_f32 v46, v46, v66
    v_add_f32 v47, v47, v67
    v_add_f32 v48, v48, v68
    v_add_f32 v49, v49, v69
    v_add_f32 v50, v50, v70
    v_add_f32 v51, v51, v71
    s_waitcnt lgkmcnt(0)
    v_add_f32 v44, v44, v52
    v_add_f32 v45, v45, v53
    v_add_f32 v46, v46, v54
    v_add_f32 v47, v47, v55
    v_add_f32 v48, v48, v56
    v_add_f32 v49, v49, v57
    v_add_f32 v50, v50, v58
    v_add_f32 v51, v51, v59
    s_waitcnt vmcnt(0)
    v_lshlrev_b32 v52, 16, v12
    v_and_b32 v53, 0xffff0000, v12
    v_add_f32 v32, v32, v52
    v_add_f32 v33, v33, v53
    v_lshlrev_b32 v52, 16, v13
    v_and_b32 v53, 0xffff0000, v13
    v_add_f32 v34, v34, v52
    v_add_f32 v35, v35, v53
    v_lshlrev_b32 v52, 16, v14
    v_and_b32 v53, 0xffff0000, v14
    v_add_f32 v36, v36, v52
    v_add_f32 v37, v37, v53
    v_lshlrev_b32 v52, 16, v15
    v_and_b32 v53, 0xffff0000, v15
    v_add_f32 v38, v38, v52
    v_add_f32 v39, v39, v53
    v_lshlrev_b32 v52, 16, v16
    v_and_b32 v53, 0xffff0000, v16
    v_add_f32 v40, v40, v52
    v_add_f32 v41, v41, v53
    v_lshlrev_b32 v52, 16, v17
    v_and_b32 v53, 0xffff0000, v17
    v_add_f32 v42, v42, v52
    v_add_f32 v43, v43, v53
    v_lshlrev_b32 v52, 16, v18
    v_and_b32 v53, 0xffff0000, v18
    v_add_f32 v44, v44, v52
    v_add_f32 v45, v45, v53
    v_lshlrev_b32 v52, 16, v19
    v_and_b32 v53, 0xffff0000, v19
    v_add_f32 v46, v46, v52
    v_add_f32 v47, v47, v53
    v_lshlrev_b32 v52, 16, v20
    v_and_b32 v53, 0xffff0000, v20
    v_add_f32 v48, v48, v52
    v_add_f32 v49, v49, v53
    v_lshlrev_b32 v52, 16, v21
    v_and_b32 v53, 0xffff0000, v21
    v_add_f32 v50, v50, v52
    v_add_f32 v51, v51, v53
    buffer_store_dwordx4 v[32:35], v3, s[8:11], s38 offen offset:0 sc1
    buffer_store_dwordx4 v[36:39], v3, s[8:11], s38 offen offset:1024 sc1
    buffer_store_dwordx4 v[40:43], v3, s[8:11], s38 offen offset:2048 sc1
    buffer_store_dwordx4 v[44:47], v3, s[8:11], s38 offen offset:3072 sc1
    buffer_store_dwordx4 v[48:51], v7, s[8:11], s38 offen sc1
LK2_end:
    s_endpgm
.globl k3_kernel
.p2align 8
.type k3_kernel,@function
k3_kernel:
    s_cmp_ge_u32 s2, 256
    s_cbranch_scc1 LK3_end
    s_load_dwordx2 s[4:5], s[0:1], 72
    s_load_dwordx2 s[6:7], s[0:1], 0
    s_load_dwordx2 s[22:23], s[0:1], 56
    v_and_b32 v1, 63, v0
    v_lshrrev_b32 v2, 6, v0
    s_mov_b32 s3, s2
    v_readfirstlane_b32 s20, v2
LF:
    s_and_b32 s27, s3, 7
    s_lshr_b32 s28, s3, 3
    s_lshr_b32 s29, s27, 1
    s_lshl_b32 s29, s29, 3
    s_lshr_b32 s30, s28, 2
    s_add_u32 s29, s29, s30
    s_and_b32 s30, s27, 1
    s_lshl_b32 s30, s30, 2
    s_and_b32 s31, s28, 3
    s_add_u32 s30, s30, s31
    v_lshlrev_b32 v3, 4, v1
    v_add_u32 v4, 69632, v3
    v_add_u32 v5, 139264, v3
    v_add_u32 v6, 208896, v3
    v_add_u32 v7, 4096, v3
    s_mul_i32 s32, s20, 5
    s_add_u32 s32, s32, 0
    s_mul_i32 s33, s29, 278528
    s_lshl_b32 s34, s32, 10
    s_add_u32 s33, s33, s34
    s_add_u32 s33, s33, 7864320
    s_mul_i32 s34, s32, 40960
    s_mul_i32 s35, s30, 5120
    s_add_u32 s34, s34, s35
    s_add_u32 s34, s34, 16777216
    s_waitcnt lgkmcnt(0)
    s_mov_b32 s8, s4
    s_mov_b32 s9, s5
    s_mov_b32 s10, 268435456
    s_mov_b32 s11, 0x00020000
    s_mov_b32 s12, s6
    s_mov_b32 s13, s7
    s_mov_b32 s14, 2621440
    s_mov_b32 s15, 0x00020000
    s_mov_b32 s16, s22
    s_mov_b32 s17, s23
    s_mov_b32 s18, 2621440
    s_mov_b32 s19, 0x00020000
    buffer_load_dwordx4 v[28:31], v3, s[8:11], s34 offen offset:0
    buffer_load_dwordx4 v[32:35], v3, s[8:11], s34 offen offset:1024
    buffer_load_dwordx4 v[36:39], v3, s[8:11], s34 offen offset:2048
    buffer_load_dwordx4 v[40:43], v3, s[8:11], s34 offen offset:3072
    buffer_load_dwordx4 v[44:47], v7, s[8:11], s34 offen
    s_add_u32 s34, s34, 40960
    buffer_load_dwordx4 v[12:15], v3, s[8:11], s33 offen
    buffer_load_dwordx4 v[16:19], v4, s[8:11], s33 offen
    buffer_load_dwordx4 v[20:23], v5, s[8:11], s33 offen
    buffer_load_dwordx4 v[24:27], v6, s[8:11], s33 offen
    s_add_u32 s33, s33, 1024
    buffer_load_dwordx4 v[64:67], v3, s[8:11], s34 offen offset:0
    buffer_load_dwordx4 v[68:71], v3, s[8:11], s34 offen offset:1024
    buffer_load_dwordx4 v[72:75], v3, s[8:11], s34 offen offset:2048
    buffer_load_dwordx4 v[76:79], v3, s[8:11], s34 offen offset:3072
    buffer_load_dwordx4 v[80:83], v7, s[8:11], s34 offen
    s_add_u32 s34, s34, 40960
    buffer_load_dwordx4 v[48:51], v3, s[8:11], s33 offen
    buffer_load_dwordx4 v[52:55], v4, s[8:11], s33 offen
    buffer_load_dwordx4 v[56:59], v5, s[8:11], s33 offen
    buffer_load_dwordx4 v[60:63], v6, s[8:11], s33 offen
    s_add_u32 s33, s33, 1024
    buffer_load_dwordx4 v[100:103], v3, s[8:11], s34 offen offset:0
    buffer_load_dwordx4 v[104:107], v3, s[8:11], s34 offen offset:1024
    buffer_load_dwordx4 v[108:111], v3, s[8:11], s34 offen offset:2048
    buffer_load_dwordx4 v[112:115], v3, s[8:11], s34 offen offset:3072
    buffer_load_dwordx4 v[116:119], v7, s[8:11], s34 offen
    s_add_u32 s34, s34, 40960
    buffer_load_dwordx4 v[84:87], v3, s[8:11], s33 offen
    buffer_load_dwordx4 v[88:91], v4, s[8:11], s33 offen
    buffer_load_dwordx4 v[92:95], v5, s[8:11], s33 offen
    buffer_load_dwordx4 v[96:99], v6, s[8:11], s33 offen
    s_add_u32 s33, s33, 1024
    buffer_load_dwordx4 v[136:139], v3, s[8:11], s34 offen offset:0
    buffer_load_dwordx4 v[140:143], v3, s[8:11], s34 offen offset:1024
    buffer_load_dwordx4 v[144:147], v3, s[8:11], s34 offen offset:2048
    buffer_load_dwordx4 v[148:151], v3, s[8:11], s34 offen offset:3072
    buffer_load_dwordx4 v[152:155], v7, s[8:11], s34 offen
    s_add_u32 s34, s34, 40960
    buffer_load_dwordx4 v[120:123], v3, s[8:11], s33 offen
    buffer_load_dwordx4 v[124:127], v4, s[8:11], s33 offen
    buffer_load_dwordx4 v[128:131], v5, s[8:11], s33 offen
    buffer_load_dwordx4 v[132:135], v6, s[8:11], s33 offen
    s_add_u32 s33, s33, 1024
    buffer_load_dwordx4 v[172:175], v3, s[8:11], s34 offen offset:0
    buffer_load_dwordx4 v[176:179], v3, s[8:11], s34 offen offset:1024
    buffer_load_dwordx4 v[180:183], v3, s[8:11], s34 offen offset:2048
    buffer_load_dwordx4 v[184:187], v3, s[8:11], s34 offen offset:3072
    buffer_load_dwordx4 v[188:191], v7, s[8:11], s34 offen
    s_add_u32 s34, s34, 40960
    buffer_load_dwordx4 v[156:159], v3, s[8:11], s33 offen
    buffer_load_dwordx4 v[160:163], v4, s[8:11], s33 offen
    buffer_load_dwordx4 v[164:167], v5, s[8:11], s33 offen
    buffer_load_dwordx4 v[168:171], v6, s[8:11], s33 offen
    s_add_u32 s33, s33, 1024
    s_lshl_b32 s36, s29, 6
    s_lshl_b32 s37, s20, 4
    s_add_u32 s36, s36, s37
    v_and_b32 v8, 15, v1
    v_add_u32 v8, s36, v8
    v_mul_u32_u24 v8, 1280, v8
    v_lshrrev_b32 v9, 4, v1
    v_lshl_add_u32 v8, v9, 3, v8
    s_mul_i32 s36, s30, 160
    s_lshl_b32 s38, s29, 3
    s_add_u32 s38, s38, s30
    s_mul_i32 s38, s38, 20480
    s_mul_i32 s39, s20, 5120
    s_add_u32 s38, s38, s39
    s_add_u32 s38, s38, 20971520
    buffer_load_dwordx4 v[192:195], v3, s[8:11], s38 offen offset:0
    buffer_load_dwordx4 v[196:199], v3, s[8:11], s38 offen offset:1024
    buffer_load_dwordx4 v[200:203], v3, s[8:11], s38 offen offset:2048
    buffer_load_dwordx4 v[204:207], v3, s[8:11], s38 offen offset:3072
    buffer_load_dwordx4 v[208:211], v7, s[8:11], s38 offen
    s_waitcnt vmcnt(41)
    v_mfma_f32_16x16x32_bf16 a[0:3], v[28:31], v[12:15], 0
    v_mfma_f32_16x16x32_bf16 a[4:7], v[32:35], v[12:15], 0
    v_mfma_f32_16x16x32_bf16 a[8:11], v[36:39], v[12:15], 0
    v_mfma_f32_16x16x32_bf16 a[12:15], v[40:43], v[12:15], 0
    v_mfma_f32_16x16x32_bf16 a[16:19], v[44:47], v[12:15], 0
    v_mfma_f32_16x16x32_bf16 a[20:23], v[28:31], v[16:19], 0
    v_mfma_f32_16x16x32_bf16 a[24:27], v[32:35], v[16:19], 0
    v_mfma_f32_16x16x32_bf16 a[28:31], v[36:39], v[16:19], 0
    v_mfma_f32_16x16x32_bf16 a[32:35], v[40:43], v[16:19], 0
    v_mfma_f32_16x16x32_bf16 a[36:39], v[44:47], v[16:19], 0
    v_mfma_f32_16x16x32_bf16 a[40:43], v[28:31], v[20:23], 0
    v_mfma_f32_16x16x32_bf16 a[44:47], v[32:35], v[20:23], 0
    v_mfma_f32_16x16x32_bf16 a[48:51], v[36:39], v[20:23], 0
    v_mfma_f32_16x16x32_bf16 a[52:55], v[40:43], v[20:23], 0
    v_mfma_f32_16x16x32_bf16 a[56:59], v[44:47], v[20:23], 0
    v_mfma_f32_16x16x32_bf16 a[60:63], v[28:31], v[24:27], 0
    v_mfma_f32_16x16x32_bf16 a[64:67], v[32:35], v[24:27], 0
    v_mfma_f32_16x16x32_bf16 a[68:71], v[36:39], v[24:27], 0
    v_mfma_f32_16x16x32_bf16 a[72:75], v[40:43], v[24:27], 0
    v_mfma_f32_16x16x32_bf16 a[76:79], v[44:47], v[24:27], 0
    s_waitcnt vmcnt(32)
    v_mfma_f32_16x16x32_bf16 a[0:3], v[64:67], v[48:51], a[0:3]
    v_mfma_f32_16x16x32_bf16 a[4:7], v[68:71], v[48:51], a[4:7]
    v_mfma_f32_16x16x32_bf16 a[8:11], v[72:75], v[48:51], a[8:11]
    v_mfma_f32_16x16x32_bf16 a[12:15], v[76:79], v[48:51], a[12:15]
    v_mfma_f32_16x16x32_bf16 a[16:19], v[80:83], v[48:51], a[16:19]
    v_mfma_f32_16x16x32_bf16 a[20:23], v[64:67], v[52:55], a[20:23]
    v_mfma_f32_16x16x32_bf16 a[24:27], v[68:71], v[52:55], a[24:27]
    v_mfma_f32_16x16x32_bf16 a[28:31], v[72:75], v[52:55], a[28:31]
    v_mfma_f32_16x16x32_bf16 a[32:35], v[76:79], v[52:55], a[32:35]
    v_mfma_f32_16x16x32_bf16 a[36:39], v[80:83], v[52:55], a[36:39]
    v_mfma_f32_16x16x32_bf16 a[40:43], v[64:67], v[56:59], a[40:43]
    v_mfma_f32_16x16x32_bf16 a[44:47], v[68:71], v[56:59], a[44:47]
    v_mfma_f32_16x16x32_bf16 a[48:51], v[72:75], v[56:59], a[48:51]
    v_mfma_f32_16x16x32_bf16 a[52:55], v[76:79], v[56:59], a[52:55]
    v_mfma_f32_16x16x32_bf16 a[56:59], v[80:83], v[56:59], a[56:59]
    v_mfma_f32_16x16x32_bf16 a[60:63], v[64:67], v[60:63], a[60:63]
    v_mfma_f32_16x16x32_bf16 a[64:67], v[68:71], v[60:63], a[64:67]
    v_mfma_f32_16x16x32_bf16 a[68:71], v[72:75], v[60:63], a[68:71]
    v_mfma_f32_16x16x32_bf16 a[72:75], v[76:79], v[60:63], a[72:75]
    v_mfma_f32_16x16x32_bf16 a[76:79], v[80:83], v[60:63], a[76:79]
    s_waitcnt vmcnt(23)
    v_mfma_f32_16x16x32_bf16 a[0:3], v[100:103], v[84:87], a[0:3]
    v_mfma_f32_16x16x32_bf16 a[4:7], v[104:107], v[84:87], a[4:7]
    v_mfma_f32_16x16x32_bf16 a[8:11], v[108:111], v[84:87], a[8:11]
    v_mfma_f32_16x16x32_bf16 a[12:15], v[112:115], v[84:87], a[12:15]
    v_mfma_f32_16x16x32_bf16 a[16:19], v[116:119], v[84:87], a[16:19]
    v_mfma_f32_16x16x32_bf16 a[20:23], v[100:103], v[88:91], a[20:23]
    v_mfma_f32_16x16x32_bf16 a[24:27], v[104:107], v[88:91], a[24:27]
    v_mfma_f32_16x16x32_bf16 a[28:31], v[108:111], v[88:91], a[28:31]
    v_mfma_f32_16x16x32_bf16 a[32:35], v[112:115], v[88:91], a[32:35]
    v_mfma_f32_16x16x32_bf16 a[36:39], v[116:119], v[88:91], a[36:39]
    v_mfma_f32_16x16x32_bf16 a[40:43], v[100:103], v[92:95], a[40:43]
    v_mfma_f32_16x16x32_bf16 a[44:47], v[104:107], v[92:95], a[44:47]
    v_mfma_f32_16x16x32_bf16 a[48:51], v[108:111], v[92:95], a[48:51]
    v_mfma_f32_16x16x32_bf16 a[52:55], v[112:115], v[92:95], a[52:55]
    v_mfma_f32_16x16x32_bf16 a[56:59], v[116:119], v[92:95], a[56:59]
    v_mfma_f32_16x16x32_bf16 a[60:63], v[100:103], v[96:99], a[60:63]
    v_mfma_f32_16x16x32_bf16 a[64:67], v[104:107], v[96:99], a[64:67]
    v_mfma_f32_16x16x32_bf16 a[68:71], v[108:111], v[96:99], a[68:71]
    v_mfma_f32_16x16x32_bf16 a[72:75], v[112:115], v[96:99], a[72:75]
    v_mfma_f32_16x16x32_bf16 a[76:79], v[116:119], v[96:99], a[76:79]
    s_waitcnt vmcnt(14)
    v_mfma_f32_16x16x32_bf16 a[0:3], v[136:139], v[120:123], a[0:3]
    v_mfma_f32_16x16x32_bf16 a[4:7], v[140:143], v[120:123], a[4:7]
    v_mfma_f32_16x16x32_bf16 a[8:11], v[144:147], v[120:123], a[8:11]
    v_mfma_f32_16x16x32_bf16 a[12:15], v[148:151], v[120:123], a[12:15]
    v_mfma_f32_16x16x32_bf16 a[16:19], v[152:155], v[120:123], a[16:19]
    v_mfma_f32_16x16x32_bf16 a[20:23], v[136:139], v[124:127], a[20:23]
    v_mfma_f32_16x16x32_bf16 a[24:27], v[140:143], v[124:127], a[24:27]
    v_mfma_f32_16x16x32_bf16 a[28:31], v[144:147], v[124:127], a[28:31]
    v_mfma_f32_16x16x32_bf16 a[32:35], v[148:151], v[124:127], a[32:35]
    v_mfma_f32_16x16x32_bf16 a[36:39], v[152:155], v[124:127], a[36:39]
    v_mfma_f32_16x16x32_bf16 a[40:43], v[136:139], v[128:131], a[40:43]
    v_mfma_f32_16x16x32_bf16 a[44:47], v[140:143], v[128:131], a[44:47]
    v_mfma_f32_16x16x32_bf16 a[48:51], v[144:147], v[128:131], a[48:51]
    v_mfma_f32_16x16x32_bf16 a[52:55], v[148:151], v[128:131], a[52:55]
    v_mfma_f32_16x16x32_bf16 a[56:59], v[152:155], v[128:131], a[56:59]
    v_mfma_f32_16x16x32_bf16 a[60:63], v[136:139], v[132:135], a[60:63]
    v_mfma_f32_16x16x32_bf16 a[64:67], v[140:143], v[132:135], a[64:67]
    v_mfma_f32_16x16x32_bf16 a[68:71], v[144:147], v[132:135], a[68:71]
    v_mfma_f32_16x16x32_bf16 a[72:75], v[148:151], v[132:135], a[72:75]
    v_mfma_f32_16x16x32_bf16 a[76:79], v[152:155], v[132:135], a[76:79]
    s_waitcnt vmcnt(5)
    v_mfma_f32_16x16x32_bf16 a[0:3], v[172:175], v[156:159], a[0:3]
    v_mfma_f32_16x16x32_bf16 a[4:7], v[176:179], v[156:159], a[4:7]
    v_mfma_f32_16x16x32_bf16 a[8:11], v[180:183], v[156:159], a[8:11]
    v_mfma_f32_16x16x32_bf16 a[12:15], v[184:187], v[156:159], a[12:15]
    v_mfma_f32_16x16x32_bf16 a[16:19], v[188:191], v[156:159], a[16:19]
    v_mfma_f32_16x16x32_bf16 a[20:23], v[172:175], v[160:163], a[20:23]
    v_mfma_f32_16x16x32_bf16 a[24:27], v[176:179], v[160:163], a[24:27]
    v_mfma_f32_16x16x32_bf16 a[28:31], v[180:183], v[160:163], a[28:31]
    v_mfma_f32_16x16x32_bf16 a[32:35], v[184:187], v[160:163], a[32:35]
    v_mfma_f32_16x16x32_bf16 a[36:39], v[188:191], v[160:163], a[36:39]
    v_mfma_f32_16x16x32_bf16 a[40:43], v[172:175], v[164:167], a[40:43]
    v_mfma_f32_16x16x32_bf16 a[44:47], v[176:179], v[164:167], a[44:47]
    v_mfma_f32_16x16x32_bf16 a[48:51], v[180:183], v[164:167], a[48:51]
    v_mfma_f32_16x16x32_bf16 a[52:55], v[184:187], v[164:167], a[52:55]
    v_mfma_f32_16x16x32_bf16 a[56:59], v[188:191], v[164:167], a[56:59]
    v_mfma_f32_16x16x32_bf16 a[60:63], v[172:175], v[168:171], a[60:63]
    v_mfma_f32_16x16x32_bf16 a[64:67], v[176:179], v[168:171], a[64:67]
    v_mfma_f32_16x16x32_bf16 a[68:71], v[180:183], v[168:171], a[68:71]
    v_mfma_f32_16x16x32_bf16 a[72:75], v[184:187], v[168:171], a[72:75]
    v_mfma_f32_16x16x32_bf16 a[76:79], v[188:191], v[168:171], a[76:79]
    s_nop 4
    s_nop 3
    s_mul_i32 s37, s20, 15360
    v_add_u32 v9, s37, v3
    s_cmp_eq_u32 s20, 0
    s_cbranch_scc0 LF_r0n0
    ds_write_b128 v3, a[20:23] offset:15360
    ds_write_b128 v3, a[24:27] offset:16384
    ds_write_b128 v3, a[28:31] offset:17408
    ds_write_b128 v3, a[32:35] offset:18432
    ds_write_b128 v3, a[36:39] offset:19456
    ds_write_b128 v3, a[40:43] offset:30720
    ds_write_b128 v3, a[44:47] offset:31744
    ds_write_b128 v3, a[48:51] offset:32768
    ds_write_b128 v3, a[52:55] offset:33792
    ds_write_b128 v3, a[56:59] offset:34816
    ds_write_b128 v3, a[60:63] offset:46080
    ds_write_b128 v3, a[64:67] offset:47104
    ds_write_b128 v3, a[68:71] offset:48128
    ds_write_b128 v3, a[72:75] offset:49152
    ds_write_b128 v3, a[76:79] offset:50176
    v_accvgpr_read_b32 v32, a0
    v_accvgpr_read_b32 v33, a1
    v_accvgpr_read_b32 v34, a2
    v_accvgpr_read_b32 v35, a3
    v_accvgpr_read_b32 v36, a4
    v_accvgpr_read_b32 v37, a5
    v_accvgpr_read_b32 v38, a6
    v_accvgpr_read_b32 v39, a7
    v_accvgpr_read_b32 v40, a8
    v_accvgpr_read_b32 v41, a9
    v_accvgpr_read_b32 v42, a10
    v_accvgpr_read_b32 v43, a11
    v_accvgpr_read_b32 v44, a12
    v_accvgpr_read_b32 v45, a13
    v_accvgpr_read_b32 v46, a14
    v_accvgpr_read_b32 v47, a15
    v_accvgpr_read_b32 v48, a16
    v_accvgpr_read_b32 v49, a17
    v_accvgpr_read_b32 v50, a18
    v_accvgpr_read_b32 v51, a19
    s_branch LF_r0d
LF_r0n0:
    s_cmp_eq_u32 s20, 1
    s_cbranch_scc0 LF_r0n1
    ds_write_b128 v3, a[0:3] offset:0
    ds_write_b128 v3, a[4:7] offset:1024
    ds_write_b128 v3, a[8:11] offset:2048
    ds_write_b128 v3, a[12:15] offset:3072
    ds_write_b128 v3, a[16:19] offset:4096
    ds_write_b128 v3, a[40:43] offset:35840
    ds_write_b128 v3, a[44:47] offset:36864
    ds_write_b128 v3, a[48:51] offset:37888
    ds_write_b128 v3, a[52:55] offset:38912
    ds_write_b128 v3, a[56:59] offset:39936
    ds_write_b128 v3, a[60:63] offset:51200
    ds_write_b128 v3, a[64:67] offset:52224
    ds_write_b128 v3, a[68:71] offset:53248
    ds_write_b128 v3, a[72:75] offset:54272
    ds_write_b128 v3, a[76:79] offset:55296
    v_accvgpr_read_b32 v32, a20
    v_accvgpr_read_b32 v33, a21
    v_accvgpr_read_b32 v34, a22
    v_accvgpr_read_b32 v35, a23
    v_accvgpr_read_b32 v36, a24
    v_accvgpr_read_b32 v37, a25
    v_accvgpr_read_b32 v38, a26
    v_accvgpr_read_b32 v39, a27
    v_accvgpr_read_b32 v40, a28
    v_accvgpr_read_b32 v41, a29
    v_accvgpr_read_b32 v42, a30
    v_accvgpr_read_b32 v43, a31
    v_accvgpr_read_b32 v44, a32
    v_accvgpr_read_b32 v45, a33
    v_accvgpr_read_b32 v46, a34
    v_accvgpr_read_b32 v47, a35
    v_accvgpr_read_b32 v48, a36
    v_accvgpr_read_b32 v49, a37
    v_accvgpr_read_b32 v50, a38
    v_accvgpr_read_b32 v51, a39
    s_branch LF_r0d
LF_r0n1:
    s_cmp_eq_u32 s20, 2
    s_cbranch_scc0 LF_r0n2
    ds_write_b128 v3, a[0:3] offset:5120
    ds_write_b128 v3, a[4:7] offset:6144
    ds_write_b128 v3, a[8:11] offset:7168
    ds_write_b128 v3, a[12:15] offset:8192
    ds_write_b128 v3, a[16:19] offset:9216
    ds_write_b128 v3, a[20:23] offset:20480
    ds_write_b128 v3, a[24:27] offset:21504
    ds_write_b128 v3, a[28:31] offset:22528
    ds_write_b128 v3, a[32:35] offset:23552
    ds_write_b128 v3, a[36:39] offset:24576
    ds_write_b128 v3, a[60:63] offset:56320
    ds_write_b128 v3, a[64:67] offset:57344
    ds_write_b128 v3, a[68:71] offset:58368
    ds_write_b128 v3, a[72:75] offset:59392
    ds_write_b128 v3, a[76:79] offset:60416
    v_accvgpr_read_b32 v32, a40
    v_accvgpr_read_b32 v33, a41
    v_accvgpr_read_b32 v34, a42
    v_accvgpr_read_b32 v35, a43
    v_accvgpr_read_b32 v36, a44
    v_accvgpr_read_b32 v37, a45
    v_accvgpr_read_b32 v38, a46
    v_accvgpr_read_b32 v39, a47
    v_accvgpr_read_b32 v40, a48
    v_accvgpr_read_b32 v41, a49
    v_accvgpr_read_b32 v42, a50
    v_accvgpr_read_b32 v43, a51
    v_accvgpr_read_b32 v44, a52
    v_accvgpr_read_b32 v45, a53
    v_accvgpr_read_b32 v46, a54
    v_accvgpr_read_b32 v47, a55
    v_accvgpr_read_b32 v48, a56
    v_accvgpr_read_b32 v49, a57
    v_accvgpr_read_b32 v50, a58
    v_accvgpr_read_b32 v51, a59
    s_branch LF_r0d
LF_r0n2:
    ds_write_b128 v3, a[0:3] offset:10240
    ds_write_b128 v3, a[4:7] offset:11264
    ds_write_b128 v3, a[8:11] offset:12288
    ds_write_b128 v3, a[12:15] offset:13312
    ds_write_b128 v3, a[16:19] offset:14336
    ds_write_b128 v3, a[20:23] offset:25600
    ds_write_b128 v3, a[24:27] offset:26624
    ds_write_b128 v3, a[28:31] offset:27648
    ds_write_b128 v3, a[32:35] offset:28672
    ds_write_b128 v3, a[36:39] offset:29696
    ds_write_b128 v3, a[40:43] offset:40960
    ds_write_b128 v3, a[44:47] offset:41984
    ds_write_b128 v3, a[48:51] offset:43008
    ds_write_b128 v3, a[52:55] offset:44032
    ds_write_b128 v3, a[56:59] offset:45056
    v_accvgpr_read_b32 v32, a60
    v_accvgpr_read_b32 v33, a61
    v_accvgpr_read_b32 v34, a62
    v_accvgpr_read_b32 v35, a63
    v_accvgpr_read_b32 v36, a64
    v_accvgpr_read_b32 v37, a65
    v_accvgpr_read_b32 v38, a66
    v_accvgpr_read_b32 v39, a67
    v_accvgpr_read_b32 v40, a68
    v_accvgpr_read_b32 v41, a69
    v_accvgpr_read_b32 v42, a70
    v_accvgpr_read_b32 v43, a71
    v_accvgpr_read_b32 v44, a72
    v_accvgpr_read_b32 v45, a73
    v_accvgpr_read_b32 v46, a74
    v_accvgpr_read_b32 v47, a75
    v_accvgpr_read_b32 v48, a76
    v_accvgpr_read_b32 v49, a77
    v_accvgpr_read_b32 v50, a78
    v_accvgpr_read_b32 v51, a79
LF_r0d:
    s_waitcnt lgkmcnt(0)
    s_barrier
    ds_read_b128 v[52:55], v9 offset:0
    ds_read_b128 v[56:59], v9 offset:1024
    ds_read_b128 v[60:63], v9 offset:2048
    ds_read_b128 v[64:67], v9 offset:3072
    ds_read_b128 v[68:71], v9 offset:4096
    ds_read_b128 v[72:75], v9 offset:5120
    ds_read_b128 v[76:79], v9 offset:6144
    ds_read_b128 v[80:83], v9 offset:7168
    ds_read_b128 v[84:87], v9 offset:8192
    ds_read_b128 v[88:91], v9 offset:9216
    s_waitcnt lgkmcnt(5)
    v_add_f32 v32, v32, v52
    v_add_f32 v33, v33, v53
    v_add_f32 v34, v34, v54
    v_add_f32 v35, v35, v55
    v_add_f32 v36, v36, v56
    v_add_f32 v37, v37, v57
    v_add_f32 v38, v38, v58
    v_add_f32 v39, v39, v59
    v_add_f32 v40, v40, v60
    v_add_f32 v41, v41, v61
    v_add_f32 v42, v42, v62
    v_add_f32 v43, v43, v63
    v_add_f32 v44, v44, v64
    v_add_f32 v45, v45, v65
    v_add_f32 v46, v46, v66
    v_add_f32 v47, v47, v67
    v_add_f32 v48, v48, v68
    v_add_f32 v49, v49, v69
    v_add_f32 v50, v50, v70
    v_add_f32 v51, v51, v71
    ds_read_b128 v[52:55], v9 offset:10240
    ds_read_b128 v[56:59], v9 offset:11264
    ds_read_b128 v[60:63], v9 offset:12288
    ds_read_b128 v[64:67], v9 offset:13312
    ds_read_b128 v[68:71], v9 offset:14336
    s_waitcnt lgkmcnt(5)
    v_add_f32 v32, v32, v72
    v_add_f32 v33, v33, v73
    v_add_f32 v34, v34, v74
    v_add_f32 v35, v35, v75
    v_add_f32 v36, v36, v76
    v_add_f32 v37, v37, v77
    v_add_f32 v38, v38, v78
    v_add_f32 v39, v39, v79
    v_add_f32 v40, v40, v80
    v_add_f32 v41, v41, v81
    v_add_f32 v42, v42, v82
    v_add_f32 v43, v43, v83
    v_add_f32 v44, v44, v84
    v_add_f32 v45, v45, v85
    v_add_f32 v46, v46, v86
    v_add_f32 v47, v47, v87
    v_add_f32 v48, v48, v88
    v_add_f32 v49, v49, v89
    v_add_f32 v50, v50, v90
    v_add_f32 v51, v51, v91
    s_waitcnt lgkmcnt(0)
    v_add_f32 v32, v32, v52
    v_add_f32 v33, v33, v53
    v_add_f32 v34, v34, v54
    v_add_f32 v35, v35, v55
    v_add_f32 v36, v36, v56
    v_add_f32 v37, v37, v57
    v_add_f32 v38, v38, v58
    v_add_f32 v39, v39, v59
    v_add_f32 v40, v40, v60
    v_add_f32 v41, v41, v61
    v_add_f32 v42, v42, v62
    v_add_f32 v43, v43, v63
    v_add_f32 v44, v44, v64
    v_add_f32 v45, v45, v65
    v_add_f32 v46, v46, v66
    v_add_f32 v47, v47, v67
    v_add_f32 v48, v48, v68
    v_add_f32 v49, v49, v69
    v_add_f32 v50, v50, v70
    v_add_f32 v51, v51, v71
    s_waitcnt vmcnt(0)
    v_add_f32 v32, v32, v192
    v_add_f32 v33, v33, v193
    v_add_f32 v34, v34, v194
    v_add_f32 v35, v35, v195
    v_add_f32 v36, v36, v196
    v_add_f32 v37, v37, v197
    v_add_f32 v38, v38, v198
    v_add_f32 v39, v39, v199
    v_add_f32 v40, v40, v200
    v_add_f32 v41, v41, v201
    v_add_f32 v42, v42, v202
    v_add_f32 v43, v43, v203
    v_add_f32 v44, v44, v204
    v_add_f32 v45, v45, v205
    v_add_f32 v46, v46, v206
    v_add_f32 v47, v47, v207
    v_add_f32 v48, v48, v208
    v_add_f32 v49, v49, v209
    v_add_f32 v50, v50, v210
    v_add_f32 v51, v51, v211
    v_cvt_pk_bf16_f32 v52, v32, v33
    v_cvt_pk_bf16_f32 v53, v34, v35
    buffer_store_dwordx2 v[52:53], v8, s[16:19], s36 offen offset:0
    v_cvt_pk_bf16_f32 v54, v36, v37
    v_cvt_pk_bf16_f32 v55, v38, v39
    buffer_store_dwordx2 v[54:55], v8, s[16:19], s36 offen offset:32
    v_cvt_pk_bf16_f32 v56, v40, v41
    v_cvt_pk_bf16_f32 v57, v42, v43
    buffer_store_dwordx2 v[56:57], v8, s[16:19], s36 offen offset:64
    v_cvt_pk_bf16_f32 v58, v44, v45
    v_cvt_pk_bf16_f32 v59, v46, v47
    buffer_store_dwordx2 v[58:59], v8, s[16:19], s36 offen offset:96
    v_cvt_pk_bf16_f32 v60, v48, v49
    v_cvt_pk_bf16_f32 v61, v50, v51
    buffer_store_dwordx2 v[60:61], v8, s[16:19], s36 offen offset:128
LK3_end:
    s_endpgm
LCODE_END:
.section .rodata,"a"
.p2align 6
.amdhsa_kernel k1_kernel
  .amdhsa_next_free_vgpr 256
  .amdhsa_next_free_sgpr 100
  .amdhsa_accum_offset 256
  .amdhsa_group_segment_fixed_size 0
  .amdhsa_kernarg_size 80
  .amdhsa_user_sgpr_count 2
  .amdhsa_user_sgpr_kernarg_segment_ptr 1
  .amdhsa_system_sgpr_workgroup_id_x 1
.end_amdhsa_kernel
.p2align 6
.amdhsa_kernel k2_kernel
  .amdhsa_next_free_vgpr 168
  .amdhsa_next_free_sgpr 64
  .amdhsa_accum_offset 168
  .amdhsa_group_segment_fixed_size 0
  .amdhsa_kernarg_size 80
  .amdhsa_user_sgpr_count 2
  .amdhsa_user_sgpr_kernarg_segment_ptr 1
  .amdhsa_system_sgpr_workgroup_id_x 1
.end_amdhsa_kernel
.p2align 6
.amdhsa_kernel k3_kernel
  .amdhsa_next_free_vgpr 308
  .amdhsa_next_free_sgpr 60
  .amdhsa_accum_offset 228
  .amdhsa_group_segment_fixed_size 0
  .amdhsa_kernarg_size 80
  .amdhsa_user_sgpr_count 2
  .amdhsa_user_sgpr_kernarg_segment_ptr 1
  .amdhsa_system_sgpr_workgroup_id_x 1
.end_amdhsa_kernel
```
